```python
import torch

def _softmax(x, axis=-1):
    return torch.softmax(x, dim=axis)
def _gelu(x):
    return torch.nn.functional.gelu(x, approximate="tanh")
def _silu(x):
    return torch.nn.functional.silu(x)
def _sigmoid(x):
    return torch.sigmoid(x)
def _layernorm(x, axis=-1, eps=1e-5):
    m = x.mean(dim=axis, keepdim=True)
    v = x.var(dim=axis, keepdim=True, unbiased=False)
    return (x - m) / torch.sqrt(v + eps)
def _scatter_add(tgt, idx, src, axis=0):
    return tgt.clone().index_add_(axis, idx, src)
def _segment_sum(src, seg, n):
    out = torch.zeros((n,) + src.shape[1:], dtype=src.dtype)
    return out.index_add_(0, seg, src)
def _pad(x, pw):
    flat = tuple(v for pair in reversed(pw) for v in pair)
    return torch.nn.functional.pad(x, flat)

kernel_name = 'parallel_sum__gqa_block_cached__dense_activation_silu__decode'

def setup_inputs():

    _w = (lambda a: (lambda t: t.to(torch.bfloat16) if t.is_floating_point() else t)(torch.as_tensor(a)))
    def _A_setup():
        B, Sq, D = 4, 1, 512
        Hq, Hkv, Sk, Dh = 32, 8, 4096, 128
        assert Hq % Hkv == 0, (Hq, Hkv)
        return {
            "x": _w((lambda *s: torch.randn(*s, dtype=torch.bfloat16) * 0.05)(B, Sq, D)),
            "k_cache": _w((lambda *s: torch.randn(*s, dtype=torch.bfloat16) * 3.2)(B, Hkv, Sk, Dh)),
            "v_cache": _w((lambda *s: torch.randn(*s, dtype=torch.bfloat16) * 0.8)(B, Hkv, Sk, Dh)),
            "wq": _w((lambda *s: torch.randn(*s, dtype=torch.bfloat16) * 3.2)(D, Hq * Dh) * (D ** -0.5)),
            "wo": _w((lambda *s: torch.randn(*s, dtype=torch.bfloat16) * 0.8)(Hq * Dh, D) * ((Hq * Dh) ** -0.5)),
        }
    _A_in = _A_setup()

    def _B_setup():
        B, S, D, F = 4, 1, 512, 1792
        return {
            "x": _w((lambda *s: torch.randn(*s, dtype=torch.bfloat16) * 0.05)(B, S, D)),
            "w1": _w((lambda *s: torch.randn(*s, dtype=torch.bfloat16) * 3.2)(D, F) * (D ** -0.5)),
            "w2": _w((lambda *s: torch.randn(*s, dtype=torch.bfloat16) * 0.4)(F, D) * (F ** -0.5)),
        }
    _B_in = _B_setup()

    return {
        "A_x": _A_in["x"],
        "A_k_cache": _A_in["k_cache"],
        "A_v_cache": _A_in["v_cache"],
        "A_wq": _A_in["wq"],
        "A_wo": _A_in["wo"],
        "B_x": _B_in["x"],
        "B_w1": _B_in["w1"],
        "B_w2": _B_in["w2"],
    }

def reference(A_x, A_k_cache, A_v_cache, A_wq, A_wo, B_x, B_w1, B_w2):
    def _A_ref(x, k_cache, v_cache, wq, wo):
        B, Sq, D = x.shape
        Hq, Dh = 32, 128
        Hkv = k_cache.shape[1]
        rep = Hq // Hkv
        q = (lambda x, *d: x.permute(*d))((x @ wq).reshape(B, Sq, Hq, Dh), 0, 2, 1, 3)
        k = (lambda x, n, axis: torch.repeat_interleave(x, n, dim=axis))(k_cache, rep, axis=1)
        v = (lambda x, n, axis: torch.repeat_interleave(x, n, dim=axis))(v_cache, rep, axis=1)
        scores = torch.einsum("bhqd,bhkd->bhqk", q, k) * (Dh ** -0.5)
        p = _softmax(scores, axis=-1)
        o = torch.einsum("bhqk,bhkd->bhqd", p, v)
        return (lambda x, *d: x.permute(*d))(o, 0, 2, 1, 3).reshape(B, Sq, Hq * Dh) @ wo

    def _B_ref(x, w1, w2):
        h = torch.einsum("bsd,df->bsf", x, w1)
        h = _silu(h)
        out = torch.einsum("bsf,fd->bsd", h, w2)
        return out

    x = A_x
    xn = _layernorm(x, axis=-1)
    return x + _A_ref(xn, A_k_cache, A_v_cache, A_wq, A_wo) + _B_ref(xn, B_w1, B_w2)
```

```asm
; @launch grid=(256,1,1) block=(640,1,1) lds=152512
.amdgcn_target "amdgcn-amd-amdhsa--gfx950"
.text
.globl parallel_sum__gqa_block_cached__dense_activation_silu__decode_kernel
.p2align 12
.p2align 8
.type parallel_sum__gqa_block_cached__dense_activation_silu__decode_kernel,@function
parallel_sum__gqa_block_cached__dense_activation_silu__decode_kernel:
    s_load_dwordx16 s[36:51], s[0:1], 0
    s_load_dwordx4 s[52:55], s[0:1], 64
    s_load_dwordx2 s[56:57], s[0:1], 80
    s_cmp_ge_u32 s2, 256
    s_cbranch_scc1 L_end
    v_lshrrev_b32 v1, 6, v0
    v_and_b32 v0, 63, v0
    v_lshlrev_b32 v8, 4, v0
    v_readfirstlane_b32 s3, v1
    v_mov_b32 v160, 151296
    v_mov_b32 v161, 1
    s_mov_b32 s67, 262144
    s_cmp_lt_u32 s3, 2
    s_cbranch_scc1 L_svc
    s_setprio 2
    s_sub_u32 s3, s3, 2
    v_lshrrev_b32 v1, 4, v0
    v_and_b32 v2, 15, v0
    v_lshlrev_b32 v3, 2, v1
    v_xor_b32 v2, v2, v3
    v_lshlrev_b32 v1, 8, v1
    v_xor_b32 v3, 0, v2
    v_lshl_add_u32 v4, v3, 4, v1
    v_xor_b32 v3, 1, v2
    v_lshl_add_u32 v5, v3, 4, v1
    v_xor_b32 v3, 2, v2
    v_lshl_add_u32 v6, v3, 4, v1
    v_xor_b32 v3, 3, v2
    v_lshl_add_u32 v7, v3, 4, v1
    s_and_b32 s61, s2, 7
    s_lshl_b32 s61, s61, 3
    s_bfe_u32 s63, s2, 0x30003
    s_add_u32 s61, s61, s63
    s_and_b32 s64, s2, 0xc0
    s_add_u32 s61, s61, s64
    s_lshl_b32 s61, s61, 17
    s_lshl_b32 s62, s3, 14
    s_mul_i32 s63, s63, 8
    s_lshr_b32 s64, s2, 6
    s_mul_i32 s64, s64, 6
    s_add_u32 s63, s63, s64
    s_add_u32 s63, s63, s3
    s_lshl_b32 s101, s63, 10
    s_getreg_b32 s31, hwreg(HW_REG_XCC_ID)
    s_and_b32 s31, s31, 7
    s_lshl_b32 s31, s31, 3
    s_mov_b32 s4, 0xc000c
    s_mov_b32 s5, 0xc000c
    s_lshr_b64 s[4:5], s[4:5], s31
    s_and_b32 s31, s4, 0xff
    s_mov_b32 s10, 0x2000000
    s_mov_b32 s11, 0x20000
    s_mov_b32 m0, s62
    s_add_u32 s63, s101, 0
    s_and_b32 s63, s63, 0x1ffff
    s_add_u32 s63, s63, s61
    s_waitcnt lgkmcnt(0)
    s_mov_b64 s[8:9], s[38:39]
    buffer_load_dwordx4 v4, s[8:11], s63 offen nt lds
    s_add_u32 m0, s62, 1024
    s_add_u32 s63, s101, 8192
    s_and_b32 s63, s63, 0x1ffff
    s_add_u32 s63, s63, s61
    buffer_load_dwordx4 v5, s[8:11], s63 offen nt lds
    s_add_u32 m0, s62, 2048
    s_add_u32 s63, s101, 16384
    s_and_b32 s63, s63, 0x1ffff
    s_add_u32 s63, s63, s61
    buffer_load_dwordx4 v6, s[8:11], s63 offen nt lds
    s_add_u32 m0, s62, 3072
    s_add_u32 s63, s101, 24576
    s_and_b32 s63, s63, 0x1ffff
    s_add_u32 s63, s63, s61
    s_cmp_gt_u32 s31, 3
    s_cbranch_scc0 L_thr_1
    s_waitcnt vmcnt(2)
L_thr_1:
    buffer_load_dwordx4 v7, s[8:11], s63 offen nt lds
    s_branch L_stream
L_svc:
    s_cmp_eq_u32 s3, 1
    s_cbranch_scc1 L_pb
    s_lshr_b32 s63, s2, 6
    s_lshl_b32 s33, s63, 20
    s_lshl_b32 s32, s63, 8
    s_lshl_b32 s11, s63, 14
    s_and_b32 s63, s2, 7
    s_lshl_b32 s63, s63, 3
    s_bfe_u32 s64, s2, 0x30003
    s_add_u32 s35, s63, s64
    s_add_u32 s11, s11, 65536
    s_mov_b32 s7, 8192
    s_mov_b32 s8, 77824
    s_mov_b32 s9, 147456
    s_mov_b32 s10, 0x10000
    s_mov_b32 s12, 4194304
    s_mov_b32 s6, 0
    v_mov_b32 v4, 0
    v_mov_b32 v5, 0
    v_mov_b32 v6, 0
    v_mov_b32 v7, 0
    ds_write_b128 v160, v[4:7]
    ds_write_b128 v160, v[4:7] offset:16
    ds_write_b128 v160, v[4:7] offset:32
    s_branch L_pj
L_pb:
    s_add_u32 s63, s2, 2
    s_and_b32 s63, s63, 7
    s_lshl_b32 s34, s63, 1
    s_lshr_b32 s64, s2, 7
    s_add_u32 s34, s34, s64
    s_cmp_lt_u32 s63, 6
    s_cbranch_scc1 L_bjob
    s_cmp_ge_u32 s2, 128
    s_cbranch_scc1 L_bnone
    s_add_u32 s34, s63, 6
L_bjob:
    s_mov_b32 s8, 12288
    s_mov_b32 s9, 148608
    s_mov_b32 s12, 1835008
    s_bfe_u32 s63, s2, 0x40003
    s_cmp_eq_u32 s63, 11
    s_cselect_b32 s64, 4, s63
    s_cmp_eq_u32 s63, 4
    s_cselect_b32 s63, 11, s64
    s_cmp_ge_u32 s63, 8
    s_cbranch_scc1 L_pb2
    s_lshr_b32 s35, s63, 2
    s_lshl_b32 s64, s34, 1
    s_add_u32 s35, s35, s64
    s_and_b32 s63, s63, 3
    s_lshl_b32 s32, s63, 8
    s_mul_i32 s33, s63, 458752
    s_mul_i32 s11, s63, 7168
    s_add_u32 s11, s11, 327680
    s_movk_i32 s7, 3584
    s_movk_i32 s10, 28672
    s_mov_b32 s6, 1
    s_branch L_pj
L_pb2:
    s_and_b32 s35, s63, 7
    s_xor_b32 s35, s35, 0
    s_lshl_b32 s33, s34, 17
    s_movk_i32 s7, 1024
    s_mov_b32 s32, 0
    s_mov_b32 s6, 2
L_pj:
    s_lshl_b32 s64, s35, 7
    s_add_u32 s33, s33, s64
    v_lshrrev_b32 v1, 3, v0
    v_and_b32 v2, 7, v0
    v_lshrrev_b32 v10, 1, v1
    v_lshlrev_b32 v10, 1, v10
    v_xor_b32 v10, v10, v2
    v_lshlrev_b32 v10, 4, v10
    v_mad_u32_u24 v10, v1, s7, v10
    s_getreg_b32 s100, hwreg(HW_REG_XCC_ID)
    s_and_b32 s100, s100, 15
    s_or_b32 s100, s100, 0x80
    s_mul_i32 s100, s100, 0x01010101
    s_and_b32 s66, s2, 7
    s_lshl_b32 s66, s66, 5
    v_and_b32 v164, 7, v0
    v_lshl_add_u32 v164, v164, 2, s66
    v_mov_b32 v11, s100
    s_lshr_b32 s65, s2, 3
    s_add_u32 s65, s65, s66
    v_mov_b32 v12, s65
    v_lshrrev_b32 v1, 4, v0
    v_and_b32 v2, 15, v0
    v_lshlrev_b32 v2, 4, v2
    v_lshl_add_u32 v1, v1, 10, v2
    s_lshl_b32 s65, s7, 3
    s_mov_b32 m0, s8
    s_mov_b32 s22, s12
    s_mov_b32 s23, 0x20000
    s_movk_i32 s30, 256
    s_mov_b32 s31, 0x20000
    s_movk_i32 s26, 4096
    s_mov_b32 s27, 0x20000
    s_cmp_eq_u32 s6, 0
    s_waitcnt lgkmcnt(0)
    s_cselect_b64 s[20:21], s[42:43], s[48:49]
    s_cmp_eq_u32 s6, 2
    s_cselect_b64 s[20:21], s[50:51], s[20:21]
    s_mov_b64 s[28:29], s[54:55]
    s_mov_b64 s[24:25], s[36:37]
    buffer_load_dwordx4 v10, s[20:23], s33 offen nt lds
    s_add_u32 m0, m0, 1024
    s_add_u32 s33, s33, s65
    buffer_load_dwordx4 v10, s[20:23], s33 offen nt lds
    s_add_u32 m0, m0, 1024
    s_add_u32 s33, s33, s65
    s_cmp_eq_u32 s6, 0
    s_cbranch_scc0 L_noreg
    s_mov_b64 exec, 1
    buffer_store_byte v11, v12, s[28:31], 0 offen
    s_mov_b64 exec, -1
L_noreg:
    s_cmp_eq_u32 s6, 2
    s_cbranch_scc1 L_nox
    buffer_load_dwordx4 v[16:19], v1, s[24:27], 0 offen offset:0
    buffer_load_dwordx4 v[20:23], v1, s[24:27], 0 offen offset:256
    buffer_load_dwordx4 v[24:27], v1, s[24:27], 0 offen offset:512
    buffer_load_dwordx4 v[28:31], v1, s[24:27], 0 offen offset:768
    buffer_load_dwordx4 v[32:35], v1, s[24:27], s32 offen
L_nox:
    buffer_load_dwordx4 v10, s[20:23], s33 offen nt lds
    s_add_u32 m0, m0, 1024
    s_add_u32 s33, s33, s65
    buffer_load_dwordx4 v10, s[20:23], s33 offen nt lds
    s_add_u32 m0, m0, 13312
    s_add_u32 s33, s33, s65
    buffer_load_dwordx4 v10, s[20:23], s33 offen nt lds
    s_add_u32 m0, m0, 1024
    s_add_u32 s33, s33, s65
    buffer_load_dwordx4 v10, s[20:23], s33 offen nt lds
    s_add_u32 m0, m0, 1024
    s_add_u32 s33, s33, s65
    buffer_load_dwordx4 v10, s[20:23], s33 offen nt lds
    s_add_u32 m0, m0, 1024
    s_add_u32 s33, s33, s65
    buffer_load_dwordx4 v10, s[20:23], s33 offen nt lds
    s_add_u32 m0, m0, 13312
    s_add_u32 s33, s33, s65
    buffer_load_dwordx4 v10, s[20:23], s33 offen nt lds
    s_add_u32 m0, m0, 1024
    s_add_u32 s33, s33, s65
    buffer_load_dwordx4 v10, s[20:23], s33 offen nt lds
    s_add_u32 m0, m0, 1024
    s_add_u32 s33, s33, s65
    buffer_load_dwordx4 v10, s[20:23], s33 offen nt lds
    s_add_u32 m0, m0, 1024
    s_add_u32 s33, s33, s65
    buffer_load_dwordx4 v10, s[20:23], s33 offen nt lds
    s_add_u32 m0, m0, 13312
    s_add_u32 s33, s33, s65
    buffer_load_dwordx4 v10, s[20:23], s33 offen nt lds
    s_add_u32 m0, m0, 1024
    s_add_u32 s33, s33, s65
    buffer_load_dwordx4 v10, s[20:23], s33 offen nt lds
    s_add_u32 m0, m0, 1024
    s_add_u32 s33, s33, s65
    buffer_load_dwordx4 v10, s[20:23], s33 offen nt lds
    s_add_u32 m0, m0, 1024
    s_add_u32 s33, s33, s65
    buffer_load_dwordx4 v10, s[20:23], s33 offen nt lds
    buffer_load_dword v165, v164, s[28:31], 0 offen sc1
    s_barrier
    s_branch L_svc2
L_stream:
    s_load_dword s58, s[56:57], 0
    s_mov_b32 s12, s40
    s_mov_b32 s13, s41
    s_mov_b32 s14, 0x2000000
    s_mov_b32 s15, 0x20000
    s_mov_b32 s16, s56
    s_mov_b32 s17, s57
    s_mov_b32 s18, 0x200000
    s_mov_b32 s19, 0x20000
    s_mov_b32 s20, s44
    s_mov_b32 s21, s45
    s_mov_b32 s22, 0x400000
    s_mov_b32 s23, 0x20000
    s_mov_b32 s72, 0xf000f
    s_mov_b32 s73, 0xf000f
    s_mov_b32 s74, 0xf000f0
    s_mov_b32 s75, 0xf000f0
    s_mov_b32 s76, 0xf000f00
    s_mov_b32 s77, 0xf000f00
    s_mov_b32 s78, 0xf000f000
    s_mov_b32 s79, 0xf000f000
    s_mov_b32 s69, 0x05040100
    s_mov_b32 s70, 0x07060302
    s_mov_b32 s68, 0xfffffc00
    s_and_b32 s63, s2, 7
    s_lshl_b32 s63, s63, 7
    s_lshr_b32 s64, s2, 3
    s_add_u32 s63, s63, s64
    s_lshl_b32 s63, s63, 9
    s_add_u32 s32, s63, 524288
    s_and_b32 s63, s2, 7
    s_lshl_b32 s63, s63, 2
    s_bfe_u32 s64, s2, 0x20003
    s_add_u32 s65, s63, s64
    s_lshl_b32 s63, s65, 14
    s_lshr_b32 s64, s3, 1
    s_lshl_b32 s64, s64, 12
    s_add_u32 s63, s63, s64
    s_and_b32 s64, s3, 1
    s_lshl_b32 s64, s64, 8
    s_add_u32 s63, s63, s64
    s_add_u32 s33, s63, 524288
    s_lshr_b32 s64, s3, 1
    s_lshl_b32 s63, s64, 5
    s_add_u32 s6, s63, 151168
    s_mul_i32 s64, s64, 272
    s_and_b32 s63, s3, 1
    s_lshl_b32 s63, s63, 7
    s_add_u32 s63, s63, s64
    s_add_u32 s7, s63, 151360
    s_lshr_b32 s63, s2, 5
    s_mul_i32 s64, s63, 48
    s_add_u32 s64, s64, s65
    s_lshl_b32 s64, s64, 10
    s_add_u32 s34, s64, 1048576
    s_lshl_b32 s64, s3, 8
    s_add_u32 s34, s34, s64
    s_lshl_b32 s35, s65, 17
    s_lshl_b32 s63, s63, 7
    s_add_u32 s35, s35, s63
    s_and_b32 s63, s3, 3
    s_lshl_b32 s63, s63, 11
    s_add_u32 s35, s35, s63
    s_cmp_ge_u32 s3, 6
    s_cselect_b32 s30, 8, 0
    v_and_b32 v1, 15, v0
    v_lshrrev_b32 v2, 4, v0
    v_and_b32 v3, 3, v1
    v_lshlrev_b32 v3, 2, v3
    v_lshrrev_b32 v9, 2, v1
    v_add_u32 v3, v3, v9
    v_lshlrev_b32 v3, 8, v3
    v_add_u32 v3, s62, v3
    v_xor_b32 v1, v1, v2
    v_lshl_add_u32 v162, v1, 4, v3
    v_xor_b32 v163, 64, v162
    v_xor_b32 v164, 128, v162
    v_xor_b32 v165, 192, v162
    v_and_b32 v9, 3, v0
    v_mul_u32_u24 v9, 288, v9
    v_lshl_add_u32 v9, v2, 4, v9
    v_add_u32 v9, 149760, v9
    v_and_b32 v1, 3, v0
    v_lshlrev_b32 v1, 5, v1
    v_add_u32 v12, 150912, v1
    s_lshl_b32 s63, s3, 2
    v_add_u32 v13, s63, v12
    v_lshlrev_b32 v14, 2, v0
    v_add_u32 v14, s62, v14
    s_and_b32 s64, s3, 1
    s_lshl_b32 s64, s64, 10
    v_add_u32 v1, s64, v8
    v_add_u32 v2, 0x10000, v1
    v_lshrrev_b32 v3, 9, v1
    v_lshlrev_b32 v3, 14, v3
    v_and_b32 v10, 0x1ff, v1
    v_add_u32 v3, v3, v10
    s_add_u32 m0, s62, 4096
    s_add_u32 s63, s101, 32768
    s_and_b32 s63, s63, 0x1ffff
    s_add_u32 s63, s63, s61
    s_barrier
    s_waitcnt vmcnt(3)
    s_cmp_gt_u32 s31, 4
    s_cbranch_scc0 L_thr_4
    s_waitcnt vmcnt(2)
L_thr_4:
    buffer_load_dwordx4 v4, s[8:11], s63 offen nt lds
    s_add_u32 m0, s62, 5120
    s_add_u32 s63, s101, 40960
    s_and_b32 s63, s63, 0x1ffff
    s_add_u32 s63, s63, s61
    s_waitcnt vmcnt(3)
    s_cmp_gt_u32 s31, 5
    s_cbranch_scc0 L_thr_5
    s_waitcnt vmcnt(2)
L_thr_5:
    buffer_load_dwordx4 v5, s[8:11], s63 offen nt lds
    s_add_u32 m0, s62, 6144
    s_add_u32 s63, s101, 49152
    s_and_b32 s63, s63, 0x1ffff
    s_add_u32 s63, s63, s61
    s_waitcnt vmcnt(3)
    s_cmp_gt_u32 s31, 6
    s_cbranch_scc0 L_thr_6
    s_waitcnt vmcnt(2)
L_thr_6:
    buffer_load_dwordx4 v6, s[8:11], s63 offen nt lds
    s_add_u32 m0, s62, 7168
    s_add_u32 s63, s101, 57344
    s_and_b32 s63, s63, 0x1ffff
    s_add_u32 s63, s63, s61
    s_waitcnt vmcnt(3)
    s_cmp_gt_u32 s31, 7
    s_cbranch_scc0 L_thr_7
    s_waitcnt vmcnt(2)
L_thr_7:
    buffer_load_dwordx4 v7, s[8:11], s63 offen nt lds
    s_add_u32 m0, s62, 8192
    s_add_u32 s63, s101, 65536
    s_and_b32 s63, s63, 0x1ffff
    s_add_u32 s63, s63, s61
    s_waitcnt vmcnt(3)
    s_cmp_gt_u32 s31, 8
    s_cbranch_scc0 L_thr_8
    s_waitcnt vmcnt(2)
L_thr_8:
    buffer_load_dwordx4 v4, s[8:11], s63 offen nt lds
    s_add_u32 m0, s62, 9216
    s_add_u32 s63, s101, 73728
    s_and_b32 s63, s63, 0x1ffff
    s_add_u32 s63, s63, s61
    s_waitcnt vmcnt(3)
    s_cmp_gt_u32 s31, 9
    s_cbranch_scc0 L_thr_9
    s_waitcnt vmcnt(2)
L_thr_9:
    buffer_load_dwordx4 v5, s[8:11], s63 offen nt lds
    s_add_u32 m0, s62, 10240
    s_add_u32 s63, s101, 81920
    s_and_b32 s63, s63, 0x1ffff
    s_add_u32 s63, s63, s61
    s_waitcnt vmcnt(3)
    s_cmp_gt_u32 s31, 10
    s_cbranch_scc0 L_thr_10
    s_waitcnt vmcnt(2)
L_thr_10:
    buffer_load_dwordx4 v6, s[8:11], s63 offen nt lds
    s_add_u32 m0, s62, 11264
    s_add_u32 s63, s101, 90112
    s_and_b32 s63, s63, 0x1ffff
    s_add_u32 s63, s63, s61
    s_waitcnt vmcnt(3)
    s_cmp_gt_u32 s31, 11
    s_cbranch_scc0 L_thr_11
    s_waitcnt vmcnt(2)
L_thr_11:
    buffer_load_dwordx4 v7, s[8:11], s63 offen nt lds
L_spin_12:
    ds_read_b32 v166, v160 offset:12
    s_waitcnt lgkmcnt(0)
    v_readfirstlane_b32 s4, v166
    s_cmp_lt_u32 s4, 2
    s_cbranch_scc1 L_spin_12
    s_add_u32 m0, s62, 12288
    s_add_u32 s63, s101, 98304
    s_and_b32 s63, s63, 0x1ffff
    s_add_u32 s63, s63, s61
    s_waitcnt vmcnt(3)
    buffer_load_dwordx4 v4, s[8:11], s63 offen nt lds
    s_add_u32 m0, s62, 13312
    s_add_u32 s63, s101, 106496
    s_and_b32 s63, s63, 0x1ffff
    s_add_u32 s63, s63, s61
    s_waitcnt vmcnt(3)
    buffer_load_dwordx4 v5, s[8:11], s63 offen nt lds
    s_add_u32 m0, s62, 14336
    s_add_u32 s63, s101, 114688
    s_and_b32 s63, s63, 0x1ffff
    s_add_u32 s63, s63, s61
    s_waitcnt vmcnt(3)
    buffer_load_dwordx4 v6, s[8:11], s63 offen nt lds
    s_cmp_lg_u32 s3, 0
    s_cbranch_scc1 L_nogo
    s_mov_b64 exec, 1
    ds_add_u32 v160, v161 offset:16
    s_mov_b64 exec, -1
L_nogo:
    s_add_u32 m0, s62, 15360
    s_add_u32 s63, s101, 122880
    s_and_b32 s63, s63, 0x1ffff
    s_add_u32 s63, s63, s61
    s_waitcnt vmcnt(3)
    buffer_load_dwordx4 v7, s[8:11], s63 offen nt lds
    s_add_u32 s63, s101, 0
    s_and_b32 s63, s63, 0x1ffff
    s_add_u32 s63, s63, s61
    s_waitcnt vmcnt(3)
    buffer_load_dwordx4 v[16:19], v8, s[12:15], s63 offen nt
    s_add_u32 s63, s101, 8192
    s_and_b32 s63, s63, 0x1ffff
    s_add_u32 s63, s63, s61
    s_waitcnt vmcnt(3)
    buffer_load_dwordx4 v[20:23], v8, s[12:15], s63 offen nt
    s_add_u32 s63, s101, 16384
    s_and_b32 s63, s63, 0x1ffff
    s_add_u32 s63, s63, s61
    s_waitcnt vmcnt(3)
    buffer_load_dwordx4 v[24:27], v8, s[12:15], s63 offen nt
    s_add_u32 s63, s101, 24576
    s_and_b32 s63, s63, 0x1ffff
    s_add_u32 s63, s63, s61
    s_waitcnt vmcnt(3)
    buffer_load_dwordx4 v[28:31], v8, s[12:15], s63 offen nt
    s_add_u32 s63, s101, 32768
    s_and_b32 s63, s63, 0x1ffff
    s_add_u32 s63, s63, s61
    s_waitcnt vmcnt(3)
    buffer_load_dwordx4 v[32:35], v8, s[12:15], s63 offen nt
    s_add_u32 s63, s101, 40960
    s_and_b32 s63, s63, 0x1ffff
    s_add_u32 s63, s63, s61
    s_waitcnt vmcnt(3)
    buffer_load_dwordx4 v[36:39], v8, s[12:15], s63 offen nt
    s_add_u32 s63, s101, 49152
    s_and_b32 s63, s63, 0x1ffff
    s_add_u32 s63, s63, s61
    s_waitcnt vmcnt(3)
    buffer_load_dwordx4 v[40:43], v8, s[12:15], s63 offen nt
    s_add_u32 s63, s101, 57344
    s_and_b32 s63, s63, 0x1ffff
    s_add_u32 s63, s63, s61
    s_waitcnt vmcnt(3)
    buffer_load_dwordx4 v[44:47], v8, s[12:15], s63 offen nt
L_spin_13:
    ds_read_b32 v166, v160 offset:0
    s_waitcnt lgkmcnt(0)
    v_readfirstlane_b32 s4, v166
    s_cmp_lt_u32 s4, 1
    s_cbranch_scc1 L_spin_13
    ds_read_b128 v[80:83], v9 offset:0
    ds_read_b128 v[84:87], v9 offset:64
    ds_read_b128 v[88:91], v9 offset:128
    ds_read_b128 v[92:95], v9 offset:192
    ds_read_b32 v166, v160 offset:32
    ds_read_b128 v[96:99], v162 offset:0
    ds_read_b128 v[100:103], v163 offset:0
    ds_read_b128 v[104:107], v164 offset:0
    ds_read_b128 v[108:111], v165 offset:0
    ds_read_b128 v[112:115], v162 offset:4096
    ds_read_b128 v[116:119], v163 offset:4096
    ds_read_b128 v[120:123], v164 offset:4096
    ds_read_b128 v[124:127], v165 offset:4096
    s_add_u32 s63, s58, 1
    s_and_b32 s59, s63, 0xf
    s_and_b32 s60, s63, 0x3ff
    s_waitcnt lgkmcnt(4)
    v_mfma_f32_16x16x32_bf16 v[128:131], v[96:99], v[80:83], 0
    v_mfma_f32_16x16x32_bf16 v[128:131], v[100:103], v[84:87], v[128:131]
    v_mfma_f32_16x16x32_bf16 v[128:131], v[104:107], v[88:91], v[128:131]
    v_mfma_f32_16x16x32_bf16 v[128:131], v[108:111], v[92:95], v[128:131]
    ds_read_b128 v[96:99], v162 offset:8192
    ds_read_b128 v[100:103], v163 offset:8192
    ds_read_b128 v[104:107], v164 offset:8192
    ds_read_b128 v[108:111], v165 offset:8192
    s_waitcnt lgkmcnt(4)
    v_mfma_f32_16x16x32_bf16 v[132:135], v[112:115], v[80:83], 0
    v_mfma_f32_16x16x32_bf16 v[132:135], v[116:119], v[84:87], v[132:135]
    v_mfma_f32_16x16x32_bf16 v[132:135], v[120:123], v[88:91], v[132:135]
    v_mfma_f32_16x16x32_bf16 v[132:135], v[124:127], v[92:95], v[132:135]
    ds_read_b128 v[112:115], v162 offset:12288
    ds_read_b128 v[116:119], v163 offset:12288
    ds_read_b128 v[120:123], v164 offset:12288
    ds_read_b128 v[124:127], v165 offset:12288
    s_waitcnt lgkmcnt(4)
    v_mfma_f32_16x16x32_bf16 v[136:139], v[96:99], v[80:83], 0
    v_mfma_f32_16x16x32_bf16 v[136:139], v[100:103], v[84:87], v[136:139]
    v_mfma_f32_16x16x32_bf16 v[136:139], v[104:107], v[88:91], v[136:139]
    v_mfma_f32_16x16x32_bf16 v[136:139], v[108:111], v[92:95], v[136:139]
    s_waitcnt lgkmcnt(0)
    v_mfma_f32_16x16x32_bf16 v[140:143], v[112:115], v[80:83], 0
    v_mfma_f32_16x16x32_bf16 v[140:143], v[116:119], v[84:87], v[140:143]
    v_mfma_f32_16x16x32_bf16 v[140:143], v[120:123], v[88:91], v[140:143]
    v_mfma_f32_16x16x32_bf16 v[140:143], v[124:127], v[92:95], v[140:143]
    v_readfirstlane_b32 s71, v166
    s_nop 1
    s_cmp_eq_u32 s30, 0
    s_cselect_b32 s71, 2, s71
    v_cvt_pk_bf16_f32 v152, v128, v129
    v_lshlrev_b32 v128, 16, v152
    v_and_b32 v129, 0xffff0000, v152
    v_mul_f32 v128, 0x3db504f3, v128
    v_mul_f32 v129, 0x3db504f3, v129
    v_cvt_pk_bf16_f32 v152, v128, v129
    v_lshlrev_b32 v128, 16, v152
    v_and_b32 v129, 0xffff0000, v152
    v_cvt_pk_bf16_f32 v152, v130, v131
    v_lshlrev_b32 v130, 16, v152
    v_and_b32 v131, 0xffff0000, v152
    v_mul_f32 v130, 0x3db504f3, v130
    v_mul_f32 v131, 0x3db504f3, v131
    v_cvt_pk_bf16_f32 v152, v130, v131
    v_lshlrev_b32 v130, 16, v152
    v_and_b32 v131, 0xffff0000, v152
    v_cvt_pk_bf16_f32 v152, v132, v133
    v_lshlrev_b32 v132, 16, v152
    v_and_b32 v133, 0xffff0000, v152
    v_mul_f32 v132, 0x3db504f3, v132
    v_mul_f32 v133, 0x3db504f3, v133
    v_cvt_pk_bf16_f32 v152, v132, v133
    v_lshlrev_b32 v132, 16, v152
    v_and_b32 v133, 0xffff0000, v152
    v_cvt_pk_bf16_f32 v152, v134, v135
    v_lshlrev_b32 v134, 16, v152
    v_and_b32 v135, 0xffff0000, v152
    v_mul_f32 v134, 0x3db504f3, v134
    v_mul_f32 v135, 0x3db504f3, v135
    v_cvt_pk_bf16_f32 v152, v134, v135
    v_lshlrev_b32 v134, 16, v152
    v_and_b32 v135, 0xffff0000, v152
    v_cvt_pk_bf16_f32 v152, v136, v137
    v_lshlrev_b32 v136, 16, v152
    v_and_b32 v137, 0xffff0000, v152
    v_mul_f32 v136, 0x3db504f3, v136
    v_mul_f32 v137, 0x3db504f3, v137
    v_cvt_pk_bf16_f32 v152, v136, v137
    v_lshlrev_b32 v136, 16, v152
    v_and_b32 v137, 0xffff0000, v152
    v_cvt_pk_bf16_f32 v152, v138, v139
    v_lshlrev_b32 v138, 16, v152
    v_and_b32 v139, 0xffff0000, v152
    v_mul_f32 v138, 0x3db504f3, v138
    v_mul_f32 v139, 0x3db504f3, v139
    v_cvt_pk_bf16_f32 v152, v138, v139
    v_lshlrev_b32 v138, 16, v152
    v_and_b32 v139, 0xffff0000, v152
    v_cvt_pk_bf16_f32 v152, v140, v141
    v_lshlrev_b32 v140, 16, v152
    v_and_b32 v141, 0xffff0000, v152
    v_mul_f32 v140, 0x3db504f3, v140
    v_mul_f32 v141, 0x3db504f3, v141
    v_cvt_pk_bf16_f32 v152, v140, v141
    v_lshlrev_b32 v140, 16, v152
    v_and_b32 v141, 0xffff0000, v152
    v_cvt_pk_bf16_f32 v152, v142, v143
    v_lshlrev_b32 v142, 16, v152
    v_and_b32 v143, 0xffff0000, v152
    v_mul_f32 v142, 0x3db504f3, v142
    v_mul_f32 v143, 0x3db504f3, v143
    v_cvt_pk_bf16_f32 v152, v142, v143
    v_lshlrev_b32 v142, 16, v152
    v_and_b32 v143, 0xffff0000, v152
    v_max3_f32 v10, v128, v129, v130
    v_max3_f32 v10, v10, v131, v132
    v_max3_f32 v10, v10, v133, v134
    v_max3_f32 v10, v10, v135, v136
    v_max3_f32 v10, v10, v137, v138
    v_max3_f32 v10, v10, v139, v140
    v_max3_f32 v10, v10, v141, v142
    v_max_f32 v10, v10, v143
    v_mov_b32 v152, v10
    s_nop 1
    v_permlane16_swap_b32 v10, v152
    s_nop 1
    v_max_f32 v10, v10, v152
    v_mov_b32 v152, v10
    s_nop 1
    v_permlane32_swap_b32 v10, v152
    s_nop 1
    v_max_f32 v10, v10, v152
    ds_write_b32 v13, v10
    s_mov_b64 exec, 1
    ds_add_u32 v160, v161 offset:4
    s_mov_b64 exec, -1
    s_add_u32 s63, s101, 65536
    s_and_b32 s63, s63, 0x1ffff
    s_add_u32 s63, s63, s61
    s_waitcnt vmcnt(3)
    buffer_load_dwordx4 v[48:51], v8, s[12:15], s63 offen nt
L_spin_14:
    ds_read_b32 v166, v160 offset:4
    s_waitcnt lgkmcnt(0)
    v_readfirstlane_b32 s4, v166
    s_cmp_lt_u32 s4, 8
    s_cbranch_scc1 L_spin_14
    ds_read_b128 v[152:155], v12
    ds_read_b128 v[156:159], v12 offset:16
    s_waitcnt lgkmcnt(0)
    v_max3_f32 v10, v152, v153, v154
    v_max3_f32 v10, v10, v155, v156
    v_max3_f32 v10, v10, v157, v158
    v_max_f32 v10, v10, v159
    v_sub_f32 v128, v128, v10
    v_sub_f32 v129, v129, v10
    v_sub_f32 v130, v130, v10
    v_sub_f32 v131, v131, v10
    v_sub_f32 v132, v132, v10
    v_sub_f32 v133, v133, v10
    v_sub_f32 v134, v134, v10
    v_sub_f32 v135, v135, v10
    v_sub_f32 v136, v136, v10
    v_sub_f32 v137, v137, v10
    v_sub_f32 v138, v138, v10
    v_sub_f32 v139, v139, v10
    v_sub_f32 v140, v140, v10
    v_sub_f32 v141, v141, v10
    v_sub_f32 v142, v142, v10
    v_sub_f32 v143, v143, v10
    v_mul_f32 v128, 0x3fb8aa3b, v128
    v_mul_f32 v129, 0x3fb8aa3b, v129
    v_mul_f32 v130, 0x3fb8aa3b, v130
    v_mul_f32 v131, 0x3fb8aa3b, v131
    v_mul_f32 v132, 0x3fb8aa3b, v132
    v_mul_f32 v133, 0x3fb8aa3b, v133
    v_mul_f32 v134, 0x3fb8aa3b, v134
    v_mul_f32 v135, 0x3fb8aa3b, v135
    v_mul_f32 v136, 0x3fb8aa3b, v136
    v_mul_f32 v137, 0x3fb8aa3b, v137
    v_mul_f32 v138, 0x3fb8aa3b, v138
    v_mul_f32 v139, 0x3fb8aa3b, v139
    v_mul_f32 v140, 0x3fb8aa3b, v140
    v_mul_f32 v141, 0x3fb8aa3b, v141
    v_mul_f32 v142, 0x3fb8aa3b, v142
    v_mul_f32 v143, 0x3fb8aa3b, v143
    v_exp_f32 v128, v128
    v_exp_f32 v129, v129
    v_exp_f32 v130, v130
    v_exp_f32 v131, v131
    v_exp_f32 v132, v132
    v_exp_f32 v133, v133
    v_exp_f32 v134, v134
    v_exp_f32 v135, v135
    v_exp_f32 v136, v136
    v_exp_f32 v137, v137
    v_exp_f32 v138, v138
    v_exp_f32 v139, v139
    v_exp_f32 v140, v140
    v_exp_f32 v141, v141
    v_exp_f32 v142, v142
    v_exp_f32 v143, v143
    v_add_f32 v11, v128, v129
    v_add_f32 v152, v130, v131
    v_add_f32 v11, v11, v132
    v_add_f32 v152, v152, v133
    v_add_f32 v11, v11, v134
    v_add_f32 v152, v152, v135
    v_add_f32 v11, v11, v136
    v_add_f32 v152, v152, v137
    v_add_f32 v11, v11, v138
    v_add_f32 v152, v152, v139
    v_add_f32 v11, v11, v140
    v_add_f32 v152, v152, v141
    v_add_f32 v11, v11, v142
    v_add_f32 v152, v152, v143
    v_add_f32 v11, v11, v152
    v_mov_b32 v152, v11
    s_nop 1
    v_permlane16_swap_b32 v11, v152
    s_nop 1
    v_add_f32 v11, v11, v152
    v_mov_b32 v152, v11
    s_nop 1
    v_permlane32_swap_b32 v11, v152
    s_nop 1
    v_add_f32 v11, v11, v152
    ds_write_b32 v13, v11 offset:128
    s_mov_b64 exec, 1
    ds_add_u32 v160, v161 offset:8
    s_mov_b64 exec, -1
    s_add_u32 s63, s101, 73728
    s_and_b32 s63, s63, 0x1ffff
    s_add_u32 s63, s63, s61
    s_waitcnt vmcnt(3)
    buffer_load_dwordx4 v[52:55], v8, s[12:15], s63 offen nt
    s_add_u32 s63, s101, 81920
    s_and_b32 s63, s63, 0x1ffff
    s_add_u32 s63, s63, s61
    s_waitcnt vmcnt(3)
    buffer_load_dwordx4 v[56:59], v8, s[12:15], s63 offen nt
    s_add_u32 s63, s101, 90112
    s_and_b32 s63, s63, 0x1ffff
    s_add_u32 s63, s63, s61
    s_waitcnt vmcnt(3)
    buffer_load_dwordx4 v[60:63], v8, s[12:15], s63 offen nt
    v_cvt_pk_bf16_f32 v152, v128, v129
    v_cvt_pk_bf16_f32 v153, v130, v131
    v_cvt_pk_bf16_f32 v154, v132, v133
    v_cvt_pk_bf16_f32 v155, v134, v135
    v_cndmask_b32 v96, 0, v152, s[72:73]
    v_cndmask_b32 v97, 0, v153, s[72:73]
    v_cndmask_b32 v98, 0, v154, s[72:73]
    v_cndmask_b32 v99, 0, v155, s[72:73]
    v_cndmask_b32 v100, 0, v152, s[74:75]
    v_cndmask_b32 v101, 0, v153, s[74:75]
    v_cndmask_b32 v102, 0, v154, s[74:75]
    v_cndmask_b32 v103, 0, v155, s[74:75]
    v_cndmask_b32 v104, 0, v152, s[76:77]
    v_cndmask_b32 v105, 0, v153, s[76:77]
    v_cndmask_b32 v106, 0, v154, s[76:77]
    v_cndmask_b32 v107, 0, v155, s[76:77]
    v_cndmask_b32 v108, 0, v152, s[78:79]
    v_cndmask_b32 v109, 0, v153, s[78:79]
    v_cndmask_b32 v110, 0, v154, s[78:79]
    v_cndmask_b32 v111, 0, v155, s[78:79]
    v_cvt_pk_bf16_f32 v152, v136, v137
    v_cvt_pk_bf16_f32 v153, v138, v139
    v_cvt_pk_bf16_f32 v154, v140, v141
    v_cvt_pk_bf16_f32 v155, v142, v143
    v_cndmask_b32 v112, 0, v152, s[72:73]
    v_cndmask_b32 v113, 0, v153, s[72:73]
    v_cndmask_b32 v114, 0, v154, s[72:73]
    v_cndmask_b32 v115, 0, v155, s[72:73]
    v_cndmask_b32 v116, 0, v152, s[74:75]
    v_cndmask_b32 v117, 0, v153, s[74:75]
    v_cndmask_b32 v118, 0, v154, s[74:75]
    v_cndmask_b32 v119, 0, v155, s[74:75]
    v_cndmask_b32 v120, 0, v152, s[76:77]
    v_cndmask_b32 v121, 0, v153, s[76:77]
    v_cndmask_b32 v122, 0, v154, s[76:77]
    v_cndmask_b32 v123, 0, v155, s[76:77]
    v_cndmask_b32 v124, 0, v152, s[78:79]
    v_cndmask_b32 v125, 0, v153, s[78:79]
    v_cndmask_b32 v126, 0, v154, s[78:79]
    v_cndmask_b32 v127, 0, v155, s[78:79]
    v_mov_b32 v15, s60
    v_lshrrev_b32 v5, 4, v0
    v_and_b32 v6, 15, v0
    v_lshlrev_b32 v7, 4, v6
    v_lshl_add_u32 v7, v5, 9, v7
    v_lshl_add_u32 v9, v5, 2, s6
    v_and_b32 v12, 1, v5
    v_lshlrev_b32 v12, 2, v12
    v_lshrrev_b32 v13, 1, v5
    v_lshl_add_u32 v12, v13, 1, v12
    v_lshl_add_u32 v12, v6, 3, v12
    v_add_u32 v12, s7, v12
    v_lshrrev_b32 v10, 3, v0
    v_and_b32 v11, 7, v0
    v_lshrrev_b32 v13, 1, v10
    v_lshlrev_b32 v13, 1, v13
    v_xor_b32 v13, v13, v11
    v_lshlrev_b32 v13, 4, v13
    s_mov_b32 s66, 8192
    v_mad_u32_u24 v13, v10, s66, v13
    v_and_b32 v4, 3, v0
    v_mul_u32_u24 v4, 272, v4
    v_lshrrev_b32 v5, 4, v0
    v_lshl_add_u32 v4, v5, 3, v4
    v_add_u32 v4, 151360, v4
    v_lshrrev_b32 v6, 2, v0
    v_and_b32 v10, 3, v0
    v_lshlrev_b32 v10, 3, v10
    v_lshl_add_u32 v10, v6, 7, v10
    v_add_u32 v10, 131072, v10
    v_bfe_u32 v6, v0, 3, 2
    v_xor_b32 v11, s3, v6
    v_lshl_add_u32 v5, v11, 5, v10
    v_perm_b32 v84, v20, v16, s70
    v_perm_b32 v85, v28, v24, s70
    v_perm_b32 v86, v36, v32, s70
    v_perm_b32 v87, v44, v40, s70
    v_perm_b32 v80, v20, v16, s69
    v_perm_b32 v81, v28, v24, s69
    v_perm_b32 v82, v36, v32, s69
    v_perm_b32 v83, v44, v40, s69
    s_nop 1
    v_mfma_f32_16x16x32_bf16 v[144:147], v[96:99], v[80:83], 0
    v_mfma_f32_16x16x32_bf16 v[148:151], v[96:99], v[84:87], 0
    v_perm_b32 v92, v21, v17, s70
    v_perm_b32 v93, v29, v25, s70
    v_perm_b32 v94, v37, v33, s70
    v_perm_b32 v95, v45, v41, s70
    v_perm_b32 v88, v21, v17, s69
    v_perm_b32 v89, v29, v25, s69
    v_perm_b32 v90, v37, v33, s69
    v_perm_b32 v91, v45, v41, s69
    s_nop 1
    v_mfma_f32_16x16x32_bf16 v[144:147], v[100:103], v[88:91], v[144:147]
    v_mfma_f32_16x16x32_bf16 v[148:151], v[100:103], v[92:95], v[148:151]
    v_perm_b32 v84, v22, v18, s70
    v_perm_b32 v85, v30, v26, s70
    v_perm_b32 v86, v38, v34, s70
    v_perm_b32 v87, v46, v42, s70
    v_perm_b32 v80, v22, v18, s69
    v_perm_b32 v81, v30, v26, s69
    v_perm_b32 v82, v38, v34, s69
    v_perm_b32 v83, v46, v42, s69
    s_nop 1
    v_mfma_f32_16x16x32_bf16 v[144:147], v[104:107], v[80:83], v[144:147]
    v_mfma_f32_16x16x32_bf16 v[148:151], v[104:107], v[84:87], v[148:151]
    v_perm_b32 v92, v23, v19, s70
    v_perm_b32 v93, v31, v27, s70
    v_perm_b32 v94, v39, v35, s70
    v_perm_b32 v95, v47, v43, s70
    v_perm_b32 v88, v23, v19, s69
    v_perm_b32 v89, v31, v27, s69
    v_perm_b32 v90, v39, v35, s69
    v_perm_b32 v91, v47, v43, s69
    s_nop 1
    v_mfma_f32_16x16x32_bf16 v[144:147], v[108:111], v[88:91], v[144:147]
    v_mfma_f32_16x16x32_bf16 v[148:151], v[108:111], v[92:95], v[148:151]
    s_add_u32 s63, s101, 98304
    s_and_b32 s63, s63, 0x1ffff
    s_add_u32 s63, s63, s61
    s_waitcnt vmcnt(3)
    buffer_load_dwordx4 v[64:67], v8, s[12:15], s63 offen nt
    s_add_u32 s63, s101, 106496
    s_and_b32 s63, s63, 0x1ffff
    s_add_u32 s63, s63, s61
    s_waitcnt vmcnt(3)
    buffer_load_dwordx4 v[68:71], v8, s[12:15], s63 offen nt
    s_add_u32 s63, s101, 114688
    s_and_b32 s63, s63, 0x1ffff
    s_add_u32 s63, s63, s61
    s_waitcnt vmcnt(3)
    buffer_load_dwordx4 v[72:75], v8, s[12:15], s63 offen nt
    s_add_u32 s63, s101, 122880
    s_and_b32 s63, s63, 0x1ffff
    s_add_u32 s63, s63, s61
    s_waitcnt vmcnt(3)
    buffer_load_dwordx4 v[76:79], v8, s[12:15], s63 offen nt
    s_cmp_lt_u32 s3, 4
    s_cbranch_scc1 L_old
    s_and_b32 s63, s3, 3
    s_lshl_b32 s63, s63, 11
    s_add_u32 m0, s63, 131072
    s_add_u32 s64, s35, 64512
    buffer_load_dwordx4 v13, s[20:23], s35 offen nt lds
    buffer_load_dwordx4 v13, s[20:23], s64 offen offset:1024 nt lds
    s_add_u32 m0, m0, 8192
    s_add_u32 s63, s35, 1024
    s_add_u32 s64, s35, 65536
    buffer_load_dwordx4 v13, s[20:23], s63 offen nt lds
    buffer_load_dwordx4 v13, s[20:23], s64 offen offset:1024 nt lds
    s_setprio 3
    s_waitcnt vmcnt(10)
    v_perm_b32 v16, v52, v48, s69
    v_perm_b32 v20, v52, v48, s70
    v_perm_b32 v24, v53, v49, s69
    v_perm_b32 v28, v53, v49, s70
    v_perm_b32 v32, v54, v50, s69
    v_perm_b32 v36, v54, v50, s70
    v_perm_b32 v40, v55, v51, s69
    v_perm_b32 v44, v55, v51, s70
    s_waitcnt vmcnt(8)
    v_perm_b32 v17, v60, v56, s69
    v_perm_b32 v21, v60, v56, s70
    v_perm_b32 v25, v61, v57, s69
    v_perm_b32 v29, v61, v57, s70
    v_perm_b32 v33, v62, v58, s69
    v_perm_b32 v37, v62, v58, s70
    v_perm_b32 v41, v63, v59, s69
    v_perm_b32 v45, v63, v59, s70
    s_waitcnt vmcnt(6)
    v_perm_b32 v18, v68, v64, s69
    v_perm_b32 v22, v68, v64, s70
    v_perm_b32 v26, v69, v65, s69
    v_perm_b32 v30, v69, v65, s70
    v_perm_b32 v34, v70, v66, s69
    v_perm_b32 v38, v70, v66, s70
    v_perm_b32 v42, v71, v67, s69
    v_perm_b32 v46, v71, v67, s70
    s_waitcnt vmcnt(4)
L_pvj:
    v_perm_b32 v19, v76, v72, s69
    v_perm_b32 v23, v76, v72, s70
    v_perm_b32 v27, v77, v73, s69
    v_perm_b32 v31, v77, v73, s70
    v_perm_b32 v35, v78, v74, s69
    v_perm_b32 v39, v78, v74, s70
    v_perm_b32 v43, v79, v75, s69
    v_perm_b32 v47, v79, v75, s70
    v_mfma_f32_16x16x32_bf16 v[144:147], v[112:115], v[16:19], v[144:147]
    v_mfma_f32_16x16x32_bf16 v[148:151], v[112:115], v[20:23], v[148:151]
    v_mfma_f32_16x16x32_bf16 v[144:147], v[116:119], v[24:27], v[144:147]
    v_mfma_f32_16x16x32_bf16 v[148:151], v[116:119], v[28:31], v[148:151]
    v_mfma_f32_16x16x32_bf16 v[144:147], v[120:123], v[32:35], v[144:147]
    v_mfma_f32_16x16x32_bf16 v[148:151], v[120:123], v[36:39], v[148:151]
    v_mfma_f32_16x16x32_bf16 v[144:147], v[124:127], v[40:43], v[144:147]
    v_mfma_f32_16x16x32_bf16 v[148:151], v[124:127], v[44:47], v[148:151]
    s_nop 7
    ds_write2st64_b32 v14, v144, v148 offset0:0 offset1:1
    ds_write2st64_b32 v14, v145, v149 offset0:2 offset1:3
    ds_write2st64_b32 v14, v146, v150 offset0:4 offset1:5
    ds_write2st64_b32 v14, v147, v151 offset0:6 offset1:7
    s_mov_b64 exec, 1
    ds_add_u32 v160, v161 offset:20
    s_mov_b64 exec, -1
    s_sub_u32 s4, s3, 2
    s_cmp_lt_u32 s4, 4
    s_cbranch_scc1 L_t2
L_t1:
    ds_read_b32 v6, v160 offset:20
    ds_read_b128 v[16:19], v1 offset:0
    ds_read_b128 v[20:23], v1 offset:16384
    ds_read_b128 v[24:27], v1 offset:32768
    ds_read_b128 v[28:31], v1 offset:49152
    ds_read_b128 v[32:35], v2 offset:0
    ds_read_b128 v[36:39], v2 offset:16384
    ds_read_b128 v[40:43], v2 offset:32768
    ds_read_b128 v[44:47], v2 offset:49152
    s_waitcnt lgkmcnt(8)
    v_readfirstlane_b32 s4, v6
    s_cmp_lt_u32 s4, s30
    s_cbranch_scc1 L_t1r
    s_waitcnt lgkmcnt(6)
    v_pk_add_f32 v[16:17], v[16:17], v[20:21]
    v_pk_add_f32 v[18:19], v[18:19], v[22:23]
    s_waitcnt lgkmcnt(5)
    v_pk_add_f32 v[16:17], v[16:17], v[24:25]
    v_pk_add_f32 v[18:19], v[18:19], v[26:27]
    s_waitcnt lgkmcnt(4)
    v_pk_add_f32 v[16:17], v[16:17], v[28:29]
    v_pk_add_f32 v[18:19], v[18:19], v[30:31]
    s_waitcnt lgkmcnt(3)
    v_pk_add_f32 v[16:17], v[16:17], v[32:33]
    v_pk_add_f32 v[18:19], v[18:19], v[34:35]
    s_waitcnt lgkmcnt(2)
    v_pk_add_f32 v[16:17], v[16:17], v[36:37]
    v_pk_add_f32 v[18:19], v[18:19], v[38:39]
    s_waitcnt lgkmcnt(1)
    v_pk_add_f32 v[16:17], v[16:17], v[40:41]
    v_pk_add_f32 v[18:19], v[18:19], v[42:43]
    s_waitcnt lgkmcnt(0)
    v_pk_add_f32 v[16:17], v[16:17], v[44:45]
    v_pk_add_f32 v[18:19], v[18:19], v[46:47]
    v_and_or_b32 v16, v16, s68, v15
    v_and_or_b32 v17, v17, s68, v15
    v_and_or_b32 v18, v18, s68, v15
    v_and_or_b32 v19, v19, s68, v15
    s_cmp_eq_u32 s71, 1
    s_cbranch_scc0 L_pl_15
    buffer_store_dwordx4 v[16:19], v3, s[16:19], s32 offen
L_pj_16:
L_t2:
    s_mov_b32 s30, 0
    s_cmp_lt_u32 s3, 4
    s_cbranch_scc1 L_t4
L_t2b:
    s_cmp_lt_u32 s3, 4
    s_cbranch_scc1 L_t2c
    s_waitcnt vmcnt(0)
    s_mov_b64 exec, 1
    ds_add_u32 v160, v161 offset:36
    s_mov_b64 exec, -1
L_t2c:
    s_mov_b32 s30, 8
L_spin_17:
    ds_read_b32 v6, v160 offset:24
    s_waitcnt lgkmcnt(0)
    v_readfirstlane_b32 s4, v6
    s_cmp_lt_u32 s4, 1
    s_cbranch_scc1 L_spin_17
    ds_read2_b32 v[152:153], v9 offset0:0 offset1:4
    s_waitcnt lgkmcnt(0)
    s_mov_b64 s[72:73], -1
    s_mov_b64 s[74:75], -1
L_t2poll:
    s_or_b64 exec, s[72:73], 1
    buffer_load_dwordx4 v[24:27], v7, s[16:19], s33 offen offset:0 sc1
    s_or_b64 exec, s[74:75], 1
    buffer_load_dwordx4 v[28:31], v7, s[16:19], s33 offen offset:2048 sc1
    s_waitcnt vmcnt(1)
    s_mov_b64 exec, s[72:73]
    v_xor_b32 v24, s60, v24
    v_xor_b32 v25, s60, v25
    v_xor_b32 v26, s60, v26
    v_xor_b32 v27, s60, v27
    v_or3_b32 v6, v24, v25, v26
    v_or_b32 v6, v6, v27
    v_and_b32 v6, 0x3ff, v6
    v_cmp_ne_u32 vcc, 0, v6
    v_mul_f32 v128, v152, v24
    v_mul_f32 v129, v152, v25
    v_mul_f32 v130, v152, v26
    v_mul_f32 v131, v152, v27
    s_mov_b64 s[72:73], vcc
    s_waitcnt vmcnt(0)
    s_mov_b64 exec, s[74:75]
    v_xor_b32 v28, s60, v28
    v_xor_b32 v29, s60, v29
    v_xor_b32 v30, s60, v30
    v_xor_b32 v31, s60, v31
    v_or3_b32 v6, v28, v29, v30
    v_or_b32 v6, v6, v31
    v_and_b32 v6, 0x3ff, v6
    v_cmp_ne_u32 vcc, 0, v6
    v_mul_f32 v132, v153, v28
    v_mul_f32 v133, v153, v29
    v_mul_f32 v134, v153, v30
    v_mul_f32 v135, v153, v31
    s_mov_b64 s[74:75], vcc
    s_or_b64 s[76:77], s[72:73], s[74:75]
    s_cbranch_scc0 L_t2ok
    s_sub_u32 s67, s67, 1
    s_cmp_gt_i32 s67, 0
    s_cbranch_scc1 L_t2poll
L_t2ok:
    s_mov_b64 exec, -1
    v_add_f32 v128, v128, v132
    v_add_f32 v129, v129, v133
    v_add_f32 v130, v130, v134
    v_add_f32 v131, v131, v135
    s_nop 0
    v_permlane32_swap_b32 v128, v129
    v_permlane32_swap_b32 v130, v131
    v_add_f32 v128, v128, v129
    v_add_f32 v130, v130, v131
    s_nop 1
    v_permlane16_swap_b32 v128, v130
    v_add_f32 v128, v128, v130
    v_cvt_pk_bf16_f32 v128, v128, v128
    ds_write_b16 v12, v128
    s_mov_b64 exec, 1
    ds_add_u32 v160, v161 offset:28
    s_mov_b64 exec, -1
    s_cmp_gt_u32 s3, 3
    s_cbranch_scc1 L_sdone
L_t4:
    ds_read_b32 v10, v160 offset:36
    ds_read_b64_tr_b16 v[96:97], v5 offset:0
    ds_read_b64_tr_b16 v[98:99], v5 offset:2048
    ds_read_b64_tr_b16 v[100:101], v5 offset:4096
    ds_read_b64_tr_b16 v[102:103], v5 offset:6144
    ds_read_b64_tr_b16 v[104:105], v5 offset:8192
    ds_read_b64_tr_b16 v[106:107], v5 offset:10240
    ds_read_b64_tr_b16 v[108:109], v5 offset:12288
    ds_read_b64_tr_b16 v[110:111], v5 offset:14336
L_t4s:
    ds_read_b32 v6, v160 offset:28
    ds_read2_b64 v[80:83], v4 offset0:0 offset1:4
    ds_read2_b64 v[84:87], v4 offset0:8 offset1:12
    ds_read2_b64 v[88:91], v4 offset0:16 offset1:20
    ds_read2_b64 v[92:95], v4 offset0:24 offset1:28
    s_waitcnt lgkmcnt(4)
    v_readfirstlane_b32 s4, v6
    v_readfirstlane_b32 s5, v10
    s_cmp_lt_u32 s4, s30
    s_cbranch_scc1 L_t4s
    s_lshl_b32 s5, s5, 1
    s_cmp_lt_u32 s5, s30
    s_cbranch_scc1 L_t4r
    s_waitcnt lgkmcnt(3)
    v_mfma_f32_16x16x32_bf16 v[144:147], v[80:83], v[96:99], 0
    s_waitcnt lgkmcnt(2)
    v_mfma_f32_16x16x32_bf16 v[144:147], v[84:87], v[100:103], v[144:147]
    s_waitcnt lgkmcnt(1)
    v_mfma_f32_16x16x32_bf16 v[144:147], v[88:91], v[104:107], v[144:147]
    s_waitcnt lgkmcnt(0)
    v_mfma_f32_16x16x32_bf16 v[144:147], v[92:95], v[108:111], v[144:147]
    s_cmp_eq_u32 s30, 0
    s_cbranch_scc1 L_t2b
    s_mov_b64 exec, 0xffff
    s_nop 4
    v_and_or_b32 v144, v144, s68, v15
    v_and_or_b32 v145, v145, s68, v15
    v_and_or_b32 v146, v146, s68, v15
    v_and_or_b32 v147, v147, s68, v15
    buffer_store_dwordx4 v[144:147], v8, s[16:19], s34 offen sc1
L_sdone:
    s_endpgm
L_pl_15:
    s_cmp_eq_u32 s71, 2
    s_cbranch_scc1 L_pj_16
    buffer_store_dwordx4 v[16:19], v3, s[16:19], s32 offen sc1
    s_branch L_pj_16
L_t1r:
    s_waitcnt lgkmcnt(0)
    s_branch L_t1
L_t4r:
    s_waitcnt lgkmcnt(0)
    s_branch L_t4
L_old:
    s_waitcnt vmcnt(6)
    v_perm_b32 v16, v52, v48, s69
    v_perm_b32 v20, v52, v48, s70
    v_perm_b32 v24, v53, v49, s69
    v_perm_b32 v28, v53, v49, s70
    v_perm_b32 v32, v54, v50, s69
    v_perm_b32 v36, v54, v50, s70
    v_perm_b32 v40, v55, v51, s69
    v_perm_b32 v44, v55, v51, s70
    s_waitcnt vmcnt(4)
    v_perm_b32 v17, v60, v56, s69
    v_perm_b32 v21, v60, v56, s70
    v_perm_b32 v25, v61, v57, s69
    v_perm_b32 v29, v61, v57, s70
    v_perm_b32 v33, v62, v58, s69
    v_perm_b32 v37, v62, v58, s70
    v_perm_b32 v41, v63, v59, s69
    v_perm_b32 v45, v63, v59, s70
    s_waitcnt vmcnt(2)
    v_perm_b32 v18, v68, v64, s69
    v_perm_b32 v22, v68, v64, s70
    v_perm_b32 v26, v69, v65, s69
    v_perm_b32 v30, v69, v65, s70
    v_perm_b32 v34, v70, v66, s69
    v_perm_b32 v38, v70, v66, s70
    v_perm_b32 v42, v71, v67, s69
    v_perm_b32 v46, v71, v67, s70
    s_waitcnt vmcnt(0)
    s_branch L_pvj
L_svc2:
    s_load_dword s58, s[56:57], 0
    s_mov_b32 s16, s56
    s_mov_b32 s17, s57
    s_mov_b32 s18, 0x200000
    s_mov_b32 s19, 0x20000
    v_and_b32 v11, 3, v0
    v_mul_u32_u24 v11, 272, v11
    v_lshrrev_b32 v1, 4, v0
    v_lshl_add_u32 v11, v1, 3, v11
    v_add_u32 v11, s9, v11
    v_lshrrev_b32 v1, 2, v0
    v_and_b32 v2, 3, v0
    v_lshlrev_b32 v2, 3, v2
    v_lshl_add_u32 v2, v1, 7, v2
    v_add_u32 v2, s8, v2
    v_bfe_u32 v1, v0, 3, 2
    v_xor_b32 v3, 0, v1
    v_lshl_add_u32 v12, v3, 5, v2
    v_xor_b32 v3, 1, v1
    v_lshl_add_u32 v13, v3, 5, v2
    v_xor_b32 v3, 2, v1
    v_lshl_add_u32 v14, v3, 5, v2
    v_xor_b32 v3, 3, v1
    v_lshl_add_u32 v15, v3, 5, v2
    s_cmp_eq_u32 s6, 2
    s_cbranch_scc1 L_b2
    s_mov_b32 s72, 0xf000f
    s_mov_b32 s73, 0xf000f
    s_mov_b32 s74, 0xf000f0
    s_mov_b32 s75, 0xf000f0
    s_mov_b32 s76, 0xf000f00
    s_mov_b32 s77, 0xf000f00
    s_mov_b32 s78, 0xf000f000
    s_mov_b32 s79, 0xf000f000
    s_waitcnt vmcnt(15)
    v_lshlrev_b32 v40, 16, v16
    v_and_b32 v41, 0xffff0000, v16
    v_lshlrev_b32 v42, 16, v17
    v_and_b32 v43, 0xffff0000, v17
    v_lshlrev_b32 v44, 16, v18
    v_and_b32 v45, 0xffff0000, v18
    v_lshlrev_b32 v46, 16, v19
    v_and_b32 v47, 0xffff0000, v19
    v_lshlrev_b32 v48, 16, v20
    v_and_b32 v49, 0xffff0000, v20
    v_lshlrev_b32 v50, 16, v21
    v_and_b32 v51, 0xffff0000, v21
    v_lshlrev_b32 v52, 16, v22
    v_and_b32 v53, 0xffff0000, v22
    v_lshlrev_b32 v54, 16, v23
    v_and_b32 v55, 0xffff0000, v23
    v_lshlrev_b32 v56, 16, v24
    v_and_b32 v57, 0xffff0000, v24
    v_lshlrev_b32 v58, 16, v25
    v_and_b32 v59, 0xffff0000, v25
    v_lshlrev_b32 v60, 16, v26
    v_and_b32 v61, 0xffff0000, v26
    v_lshlrev_b32 v62, 16, v27
    v_and_b32 v63, 0xffff0000, v27
    v_lshlrev_b32 v64, 16, v28
    v_and_b32 v65, 0xffff0000, v28
    v_lshlrev_b32 v66, 16, v29
    v_and_b32 v67, 0xffff0000, v29
    v_lshlrev_b32 v68, 16, v30
    v_and_b32 v69, 0xffff0000, v30
    v_lshlrev_b32 v70, 16, v31
    v_and_b32 v71, 0xffff0000, v31
    v_add_f32 v72, v40, v41
    v_add_f32 v74, v42, v43
    v_add_f32 v72, v72, v44
    v_add_f32 v74, v74, v45
    v_add_f32 v72, v72, v46
    v_add_f32 v74, v74, v47
    v_add_f32 v72, v72, v48
    v_add_f32 v74, v74, v49
    v_add_f32 v72, v72, v50
    v_add_f32 v74, v74, v51
    v_add_f32 v72, v72, v52
    v_add_f32 v74, v74, v53
    v_add_f32 v72, v72, v54
    v_add_f32 v74, v74, v55
    v_add_f32 v72, v72, v56
    v_add_f32 v74, v74, v57
    v_add_f32 v72, v72, v58
    v_add_f32 v74, v74, v59
    v_add_f32 v72, v72, v60
    v_add_f32 v74, v74, v61
    v_add_f32 v72, v72, v62
    v_add_f32 v74, v74, v63
    v_add_f32 v72, v72, v64
    v_add_f32 v74, v74, v65
    v_add_f32 v72, v72, v66
    v_add_f32 v74, v74, v67
    v_add_f32 v72, v72, v68
    v_add_f32 v74, v74, v69
    v_add_f32 v72, v72, v70
    v_add_f32 v74, v74, v71
    v_add_f32 v72, v72, v74
    s_nop 1
    v_add_f32_dpp v72, v72, v72 row_ror:8 row_mask:0xf bank_mask:0xf
    s_nop 1
    v_add_f32_dpp v72, v72, v72 row_ror:4 row_mask:0xf bank_mask:0xf
    s_nop 1
    v_add_f32_dpp v72, v72, v72 row_ror:2 row_mask:0xf bank_mask:0xf
    s_nop 1
    v_add_f32_dpp v72, v72, v72 row_ror:1 row_mask:0xf bank_mask:0xf
    v_mul_f32 v73, 0x3b000000, v72
    v_sub_f32 v40, v40, v73
    v_sub_f32 v41, v41, v73
    v_sub_f32 v42, v42, v73
    v_sub_f32 v43, v43, v73
    v_sub_f32 v44, v44, v73
    v_sub_f32 v45, v45, v73
    v_sub_f32 v46, v46, v73
    v_sub_f32 v47, v47, v73
    v_sub_f32 v48, v48, v73
    v_sub_f32 v49, v49, v73
    v_sub_f32 v50, v50, v73
    v_sub_f32 v51, v51, v73
    v_sub_f32 v52, v52, v73
    v_sub_f32 v53, v53, v73
    v_sub_f32 v54, v54, v73
    v_sub_f32 v55, v55, v73
    v_sub_f32 v56, v56, v73
    v_sub_f32 v57, v57, v73
    v_sub_f32 v58, v58, v73
    v_sub_f32 v59, v59, v73
    v_sub_f32 v60, v60, v73
    v_sub_f32 v61, v61, v73
    v_sub_f32 v62, v62, v73
    v_sub_f32 v63, v63, v73
    v_sub_f32 v64, v64, v73
    v_sub_f32 v65, v65, v73
    v_sub_f32 v66, v66, v73
    v_sub_f32 v67, v67, v73
    v_sub_f32 v68, v68, v73
    v_sub_f32 v69, v69, v73
    v_sub_f32 v70, v70, v73
    v_sub_f32 v71, v71, v73
    v_mul_f32 v72, v40, v40
    v_mul_f32 v74, v41, v41
    v_fmac_f32 v72, v42, v42
    v_fmac_f32 v74, v43, v43
    v_fmac_f32 v72, v44, v44
    v_fmac_f32 v74, v45, v45
    v_fmac_f32 v72, v46, v46
    v_fmac_f32 v74, v47, v47
    v_fmac_f32 v72, v48, v48
    v_fmac_f32 v74, v49, v49
    v_fmac_f32 v72, v50, v50
    v_fmac_f32 v74, v51, v51
    v_fmac_f32 v72, v52, v52
    v_fmac_f32 v74, v53, v53
    v_fmac_f32 v72, v54, v54
    v_fmac_f32 v74, v55, v55
    v_fmac_f32 v72, v56, v56
    v_fmac_f32 v74, v57, v57
    v_fmac_f32 v72, v58, v58
    v_fmac_f32 v74, v59, v59
    v_fmac_f32 v72, v60, v60
    v_fmac_f32 v74, v61, v61
    v_fmac_f32 v72, v62, v62
    v_fmac_f32 v74, v63, v63
    v_fmac_f32 v72, v64, v64
    v_fmac_f32 v74, v65, v65
    v_fmac_f32 v72, v66, v66
    v_fmac_f32 v74, v67, v67
    v_fmac_f32 v72, v68, v68
    v_fmac_f32 v74, v69, v69
    v_fmac_f32 v72, v70, v70
    v_fmac_f32 v74, v71, v71
    v_add_f32 v72, v72, v74
    s_nop 1
    v_add_f32_dpp v72, v72, v72 row_ror:8 row_mask:0xf bank_mask:0xf
    s_nop 1
    v_add_f32_dpp v72, v72, v72 row_ror:4 row_mask:0xf bank_mask:0xf
    s_nop 1
    v_add_f32_dpp v72, v72, v72 row_ror:2 row_mask:0xf bank_mask:0xf
    s_nop 1
    v_add_f32_dpp v72, v72, v72 row_ror:1 row_mask:0xf bank_mask:0xf
    v_mul_f32 v72, 0x3b000000, v72
    v_cvt_pk_bf16_f32 v72, v72, v72
    v_and_b32 v72, 0xffff0000, v72
    v_add_f32 v72, 0x3727c5ac, v72
    v_cvt_pk_bf16_f32 v72, v72, v72
    v_and_b32 v72, 0xffff0000, v72
    v_sqrt_f32 v75, v72
    s_nop 0
    v_cvt_pk_bf16_f32 v75, v75, v75
    v_and_b32 v75, 0xffff0000, v75
    v_rcp_f32 v76, v75
    v_cvt_pk_bf16_f32 v73, v73, v73
    v_and_b32 v73, 0xffff0000, v73
    v_lshlrev_b32 v40, 16, v32
    v_and_b32 v41, 0xffff0000, v32
    v_lshlrev_b32 v42, 16, v33
    v_and_b32 v43, 0xffff0000, v33
    v_lshlrev_b32 v44, 16, v34
    v_and_b32 v45, 0xffff0000, v34
    v_lshlrev_b32 v46, 16, v35
    v_and_b32 v47, 0xffff0000, v35
    v_sub_f32 v40, v40, v73
    v_sub_f32 v41, v41, v73
    v_sub_f32 v42, v42, v73
    v_sub_f32 v43, v43, v73
    v_sub_f32 v44, v44, v73
    v_sub_f32 v45, v45, v73
    v_sub_f32 v46, v46, v73
    v_sub_f32 v47, v47, v73
    v_cvt_pk_bf16_f32 v48, v40, v41
    v_cvt_pk_bf16_f32 v49, v42, v43
    v_cvt_pk_bf16_f32 v50, v44, v45
    v_cvt_pk_bf16_f32 v51, v46, v47
    v_lshlrev_b32 v40, 16, v48
    v_and_b32 v41, 0xffff0000, v48
    v_lshlrev_b32 v42, 16, v49
    v_and_b32 v43, 0xffff0000, v49
    v_lshlrev_b32 v44, 16, v50
    v_and_b32 v45, 0xffff0000, v50
    v_lshlrev_b32 v46, 16, v51
    v_and_b32 v47, 0xffff0000, v51
    v_mul_f32 v56, v40, v76
    v_fma_f32 v40, -v56, v75, v40
    v_fma_f32 v40, v40, v76, v56
    v_mul_f32 v57, v41, v76
    v_fma_f32 v41, -v57, v75, v41
    v_fma_f32 v41, v41, v76, v57
    v_mul_f32 v58, v42, v76
    v_fma_f32 v42, -v58, v75, v42
    v_fma_f32 v42, v42, v76, v58
    v_mul_f32 v59, v43, v76
    v_fma_f32 v43, -v59, v75, v43
    v_fma_f32 v43, v43, v76, v59
    v_mul_f32 v60, v44, v76
    v_fma_f32 v44, -v60, v75, v44
    v_fma_f32 v44, v44, v76, v60
    v_mul_f32 v61, v45, v76
    v_fma_f32 v45, -v61, v75, v45
    v_fma_f32 v45, v45, v76, v61
    v_mul_f32 v62, v46, v76
    v_fma_f32 v46, -v62, v75, v46
    v_fma_f32 v46, v46, v76, v62
    v_mul_f32 v63, v47, v76
    v_fma_f32 v47, -v63, v75, v47
    v_fma_f32 v47, v47, v76, v63
    v_cvt_pk_bf16_f32 v48, v40, v41
    v_cvt_pk_bf16_f32 v49, v42, v43
    v_cvt_pk_bf16_f32 v50, v44, v45
    v_cvt_pk_bf16_f32 v51, v46, v47
    s_mov_b32 s64, s9
    v_lshrrev_b32 v74, 4, v0
    v_and_b32 v77, 15, v0
    v_lshlrev_b32 v77, 4, v77
    v_mul_u32_u24 v74, 272, v74
    v_add3_u32 v74, v74, v77, s64
    ds_write_b128 v74, v[48:51]
    s_waitcnt lgkmcnt(0)
    s_add_u32 s63, s58, 1
    s_and_b32 s59, s63, 0xf
    s_and_b32 s60, s63, 0x3ff
    ds_read2_b64 v[80:83], v11 offset0:0 offset1:4
    ds_read2_b64 v[84:87], v11 offset0:8 offset1:12
    ds_read2_b64 v[88:91], v11 offset0:16 offset1:20
    ds_read2_b64 v[92:95], v11 offset0:24 offset1:28
    v_and_b32 v1, 3, v0
    v_mul_u32_u24 v1, s10, v1
    v_bfe_u32 v2, v0, 2, 2
    v_lshl_add_u32 v1, v2, 6, v1
    v_lshrrev_b32 v2, 4, v0
    v_lshl_add_u32 v1, v2, 4, v1
    s_lshl_b32 s64, s35, 8
    s_add_u32 s11, s11, s64
    v_mov_b32 v9, s59
    s_waitcnt vmcnt(1)
    ds_read_b64_tr_b16 v[96:97], v12 offset:0
    ds_read_b64_tr_b16 v[98:99], v12 offset:2048
    ds_read_b64_tr_b16 v[100:101], v12 offset:16384
    ds_read_b64_tr_b16 v[102:103], v12 offset:18432
    ds_read_b64_tr_b16 v[104:105], v12 offset:32768
    ds_read_b64_tr_b16 v[106:107], v12 offset:34816
    ds_read_b64_tr_b16 v[108:109], v12 offset:49152
    ds_read_b64_tr_b16 v[110:111], v12 offset:51200
    ds_read_b64_tr_b16 v[112:113], v13 offset:0
    ds_read_b64_tr_b16 v[114:115], v13 offset:2048
    ds_read_b64_tr_b16 v[116:117], v13 offset:16384
    ds_read_b64_tr_b16 v[118:119], v13 offset:18432
    ds_read_b64_tr_b16 v[120:121], v13 offset:32768
    ds_read_b64_tr_b16 v[122:123], v13 offset:34816
    ds_read_b64_tr_b16 v[124:125], v13 offset:49152
    ds_read_b64_tr_b16 v[126:127], v13 offset:51200
    ds_read_b64_tr_b16 v[128:129], v14 offset:0
    ds_read_b64_tr_b16 v[130:131], v14 offset:2048
    ds_read_b64_tr_b16 v[132:133], v14 offset:16384
    ds_read_b64_tr_b16 v[134:135], v14 offset:18432
    ds_read_b64_tr_b16 v[136:137], v14 offset:32768
    ds_read_b64_tr_b16 v[138:139], v14 offset:34816
    ds_read_b64_tr_b16 v[140:141], v14 offset:49152
    ds_read_b64_tr_b16 v[142:143], v14 offset:51200
    ds_read_b64_tr_b16 v[144:145], v15 offset:0
    ds_read_b64_tr_b16 v[146:147], v15 offset:2048
    ds_read_b64_tr_b16 v[148:149], v15 offset:16384
    ds_read_b64_tr_b16 v[150:151], v15 offset:18432
    ds_read_b64_tr_b16 v[152:153], v15 offset:32768
    ds_read_b64_tr_b16 v[154:155], v15 offset:34816
    ds_read_b64_tr_b16 v[156:157], v15 offset:49152
    ds_read_b64_tr_b16 v[158:159], v15 offset:51200
    s_mov_b64 exec, 1
    ds_add_u32 v160, v161 offset:12
    s_mov_b64 exec, -1
    s_waitcnt lgkmcnt(0)
    v_mfma_f32_16x16x32_bf16 v[16:19], v[96:99], v[80:83], 0
    v_mfma_f32_16x16x32_bf16 v[20:23], v[112:115], v[80:83], 0
    v_mfma_f32_16x16x32_bf16 v[24:27], v[128:131], v[80:83], 0
    v_mfma_f32_16x16x32_bf16 v[28:31], v[144:147], v[80:83], 0
    v_mfma_f32_16x16x32_bf16 v[16:19], v[100:103], v[84:87], v[16:19]
    v_mfma_f32_16x16x32_bf16 v[20:23], v[116:119], v[84:87], v[20:23]
    v_mfma_f32_16x16x32_bf16 v[24:27], v[132:135], v[84:87], v[24:27]
    v_mfma_f32_16x16x32_bf16 v[28:31], v[148:151], v[84:87], v[28:31]
    v_mfma_f32_16x16x32_bf16 v[16:19], v[104:107], v[88:91], v[16:19]
    v_mfma_f32_16x16x32_bf16 v[20:23], v[120:123], v[88:91], v[20:23]
    v_mfma_f32_16x16x32_bf16 v[24:27], v[136:139], v[88:91], v[24:27]
    v_mfma_f32_16x16x32_bf16 v[28:31], v[152:155], v[88:91], v[28:31]
    v_mfma_f32_16x16x32_bf16 v[16:19], v[108:111], v[92:95], v[16:19]
    v_mfma_f32_16x16x32_bf16 v[20:23], v[124:127], v[92:95], v[20:23]
    v_mfma_f32_16x16x32_bf16 v[24:27], v[140:143], v[92:95], v[24:27]
    v_mfma_f32_16x16x32_bf16 v[28:31], v[156:159], v[92:95], v[28:31]
    s_nop 7
    v_cndmask_b32 v16, v16, v20, s[74:75]
    v_cndmask_b32 v17, v17, v21, s[74:75]
    v_cndmask_b32 v18, v18, v22, s[74:75]
    v_cndmask_b32 v19, v19, v23, s[74:75]
    v_cndmask_b32 v16, v16, v24, s[76:77]
    v_cndmask_b32 v17, v17, v25, s[76:77]
    v_cndmask_b32 v18, v18, v26, s[76:77]
    v_cndmask_b32 v19, v19, v27, s[76:77]
    v_cndmask_b32 v16, v16, v28, s[78:79]
    v_cndmask_b32 v17, v17, v29, s[78:79]
    v_cndmask_b32 v18, v18, v30, s[78:79]
    v_cndmask_b32 v19, v19, v31, s[78:79]
    v_add_u32 v16, 8, v16
    v_add_u32 v17, 8, v17
    v_add_u32 v18, 8, v18
    v_add_u32 v19, 8, v19
    s_mov_b32 s68, 0xfffffff0
    v_and_or_b32 v16, v16, s68, v9
    v_and_or_b32 v17, v17, s68, v9
    v_and_or_b32 v18, v18, s68, v9
    v_and_or_b32 v19, v19, s68, v9
    s_waitcnt vmcnt(0)
    v_cmp_ne_u32 vcc, s100, v165
    s_nop 1
    s_cmp_eq_u64 vcc, 0
    s_cselect_b32 s71, 1, 0
    s_cbranch_scc1 L_regok
    buffer_load_dword v165, v164, s[28:31], 0 offen sc1
    s_waitcnt vmcnt(0)
    v_cmp_ne_u32 vcc, s100, v165
    s_nop 1
    s_cmp_eq_u64 vcc, 0
    s_cselect_b32 s71, 1, 0
L_regok:
    s_cmp_eq_u32 s71, 1
    s_cbranch_scc0 L_pl_2
    buffer_store_dwordx4 v[16:19], v1, s[16:19], s11 offen
L_pj_3:
    s_cmp_eq_u32 s6, 0
    s_cbranch_scc1 L_arest
    s_endpgm
L_pl_2:
    buffer_store_dwordx4 v[16:19], v1, s[16:19], s11 offen sc1
    s_branch L_pj_3
L_bnone:
    s_barrier
    s_mov_b64 exec, 1
    ds_add_u32 v160, v161 offset:12
    s_mov_b64 exec, -1
    s_endpgm
L_arest:
    s_bfe_u32 s63, s2, 0x30003
    s_cmp_lg_u32 s63, 5
    s_cbranch_scc1 L_notouch
    s_and_b32 s63, s2, 7
    s_lshl_b32 s64, s63, 20
    s_and_b32 s65, s2, 0xc0
    s_lshl_b32 s65, s65, 17
    s_add_u32 s64, s64, s65
    v_mov_b32 v1, s64
    s_lshl_b32 s63, s63, 19
    v_mov_b32 v2, s63
    s_mov_b64 exec, 1
    global_load_dword v100, v1, s[40:41] nt
    global_load_dword v101, v2, s[44:45] nt
    s_mov_b64 exec, -1
L_notouch:
    s_lshr_b32 s63, s2, 6
    s_lshl_b32 s63, s63, 16
    s_and_b32 s64, s2, 7
    s_lshl_b32 s64, s64, 11
    s_add_u32 s33, s63, s64
    s_add_u32 s33, s33, 65536
L_spin_18:
    ds_read_b32 v1, v160 offset:16
    s_waitcnt lgkmcnt(0)
    v_readfirstlane_b32 s4, v1
    s_cmp_lt_u32 s4, 1
    s_cbranch_scc1 L_spin_18
    buffer_load_dword v165, v164, s[28:31], 0 offen sc1
L_qpoll:
    s_add_u32 s63, s33, 0
    buffer_load_dwordx4 v[40:43], v8, s[16:19], s63 offen offset:0 sc1
    buffer_load_dwordx4 v[44:47], v8, s[16:19], s63 offen offset:1024 sc1
    s_add_u32 s63, s33, 16384
    buffer_load_dwordx4 v[48:51], v8, s[16:19], s63 offen offset:0 sc1
    buffer_load_dwordx4 v[52:55], v8, s[16:19], s63 offen offset:1024 sc1
    s_add_u32 s63, s33, 32768
    buffer_load_dwordx4 v[56:59], v8, s[16:19], s63 offen offset:0 sc1
    buffer_load_dwordx4 v[60:63], v8, s[16:19], s63 offen offset:1024 sc1
    s_add_u32 s63, s33, 49152
    buffer_load_dwordx4 v[64:67], v8, s[16:19], s63 offen offset:0 sc1
    buffer_load_dwordx4 v[68:71], v8, s[16:19], s63 offen offset:1024 sc1
    s_waitcnt vmcnt(0)
    v_xor_b32 v40, s59, v40
    v_xor_b32 v41, s59, v41
    v_xor_b32 v42, s59, v42
    v_xor_b32 v43, s59, v43
    v_xor_b32 v44, s59, v44
    v_xor_b32 v45, s59, v45
    v_xor_b32 v46, s59, v46
    v_xor_b32 v47, s59, v47
    v_xor_b32 v48, s59, v48
    v_xor_b32 v49, s59, v49
    v_xor_b32 v50, s59, v50
    v_xor_b32 v51, s59, v51
    v_xor_b32 v52, s59, v52
    v_xor_b32 v53, s59, v53
    v_xor_b32 v54, s59, v54
    v_xor_b32 v55, s59, v55
    v_xor_b32 v56, s59, v56
    v_xor_b32 v57, s59, v57
    v_xor_b32 v58, s59, v58
    v_xor_b32 v59, s59, v59
    v_xor_b32 v60, s59, v60
    v_xor_b32 v61, s59, v61
    v_xor_b32 v62, s59, v62
    v_xor_b32 v63, s59, v63
    v_xor_b32 v64, s59, v64
    v_xor_b32 v65, s59, v65
    v_xor_b32 v66, s59, v66
    v_xor_b32 v67, s59, v67
    v_xor_b32 v68, s59, v68
    v_xor_b32 v69, s59, v69
    v_xor_b32 v70, s59, v70
    v_xor_b32 v71, s59, v71
    v_or3_b32 v1, v40, v41, v42
    v_or3_b32 v1, v1, v43, v44
    v_or3_b32 v1, v1, v45, v46
    v_or3_b32 v1, v1, v47, v48
    v_or3_b32 v1, v1, v49, v50
    v_or3_b32 v1, v1, v51, v52
    v_or3_b32 v1, v1, v53, v54
    v_or3_b32 v1, v1, v55, v56
    v_or3_b32 v1, v1, v57, v58
    v_or3_b32 v1, v1, v59, v60
    v_or3_b32 v1, v1, v61, v62
    v_or3_b32 v1, v1, v63, v64
    v_or3_b32 v1, v1, v65, v66
    v_or3_b32 v1, v1, v67, v68
    v_or3_b32 v1, v1, v69, v70
    v_or_b32 v1, v1, v71
    v_and_b32 v1, 0xf, v1
    v_cmp_ne_u32 vcc, 0, v1
    s_cbranch_vccz L_qok
    s_sub_u32 s67, s67, 1
    s_cmp_gt_i32 s67, 0
    s_cbranch_scc1 L_qpoll
L_qok:
    v_pk_add_f32 v[40:41], v[40:41], v[48:49]
    v_pk_add_f32 v[42:43], v[42:43], v[50:51]
    v_pk_add_f32 v[44:45], v[44:45], v[52:53]
    v_pk_add_f32 v[46:47], v[46:47], v[54:55]
    v_pk_add_f32 v[40:41], v[40:41], v[56:57]
    v_pk_add_f32 v[42:43], v[42:43], v[58:59]
    v_pk_add_f32 v[44:45], v[44:45], v[60:61]
    v_pk_add_f32 v[46:47], v[46:47], v[62:63]
    v_pk_add_f32 v[40:41], v[40:41], v[64:65]
    v_pk_add_f32 v[42:43], v[42:43], v[66:67]
    v_pk_add_f32 v[44:45], v[44:45], v[68:69]
    v_pk_add_f32 v[46:47], v[46:47], v[70:71]
    v_cvt_pk_bf16_f32 v48, v40, v41
    v_cvt_pk_bf16_f32 v49, v42, v43
    v_cvt_pk_bf16_f32 v50, v44, v45
    v_cvt_pk_bf16_f32 v51, v46, v47
    v_lshrrev_b32 v1, 5, v0
    v_mul_u32_u24 v1, 288, v1
    v_and_b32 v2, 31, v0
    v_lshl_add_u32 v1, v2, 3, v1
    v_add_u32 v1, 149760, v1
    ds_write_b64 v1, v[48:49]
    ds_write_b64 v1, v[50:51] offset:576
    v_cmp_ne_u32 vcc, s100, v165
    s_nop 1
    s_cmp_eq_u64 vcc, 0
    s_cselect_b32 s71, 1, 0
    v_mov_b32 v1, s71
    ds_write_b32 v160, v1 offset:32
    s_mov_b64 exec, 1
    ds_add_u32 v160, v161 offset:0
    s_mov_b64 exec, -1
    s_mov_b32 s28, s52
    s_mov_b32 s29, s53
    s_mov_b32 s30, 0x1000
    s_mov_b32 s31, 0x20000
    s_and_b32 s34, s2, 7
    s_lshl_b32 s34, s34, 4
    s_bfe_u32 s63, s2, 0x40003
    s_or_b32 s34, s34, s63
    v_lshrrev_b32 v1, 4, v0
    v_and_b32 v2, 1, v1
    v_lshlrev_b32 v2, 11, v2
    v_lshrrev_b32 v1, 1, v1
    v_lshl_add_u32 v2, v1, 10, v2
    v_and_b32 v1, 3, v0
    v_lshl_add_u32 v12, v1, 1, v2
    s_lshl_b32 s63, s34, 3
    v_add_u32 v12, s63, v12
    s_lshr_b32 s63, s34, 4
    s_mul_i32 s63, s63, 49152
    s_and_b32 s64, s34, 15
    s_lshl_b32 s64, s64, 6
    s_add_u32 s63, s63, s64
    s_add_u32 s7, s63, 1048576
    v_lshrrev_b32 v2, 2, v0
    v_lshlrev_b32 v1, 4, v1
    v_min_u32 v3, 13, v2
    v_lshl_add_u32 v15, v3, 10, v1
    v_lshl_add_u32 v14, v2, 10, v1
    v_cmp_gt_u32 s[8:9], 14, v2
    s_and_b32 s64, s2, 7
    s_lshl_b32 s63, s64, 5
    s_lshr_b32 s6, s2, 3
    s_add_u32 s63, s63, s6
    s_lshl_b32 s63, s63, 7
    s_add_u32 s6, s63, 458752
    s_lshl_b32 s64, s64, 12
    s_bfe_u32 s63, s2, 0x20003
    s_lshl_b32 s63, s63, 3
    s_add_u32 s63, s63, s64
    s_add_u32 s35, s63, 458752
    v_and_b32 v11, 31, v0
    v_lshlrev_b32 v9, 2, v11
    v_lshlrev_b32 v11, 7, v11
    v_add_u32 v9, 151168, v9
    v_and_b32 v1, 3, v0
    v_lshlrev_b32 v3, 3, v0
    v_lshlrev_b32 v1, 5, v1
    v_add_u32 v1, 150912, v1
    buffer_load_ushort v13, v12, s[24:27], 0 offen
L_spin_19:
    ds_read_b32 v4, v160 offset:8
    s_waitcnt lgkmcnt(0)
    v_readfirstlane_b32 s4, v4
    s_cmp_lt_u32 s4, 8
    s_cbranch_scc1 L_spin_19
    ds_read_b128 v[16:19], v1
    ds_read_b128 v[20:23], v1 offset:16
    ds_read_b128 v[24:27], v1 offset:128
    ds_read_b128 v[28:31], v1 offset:144
    v_mov_b32 v2, s60
    s_waitcnt lgkmcnt(0)
    v_max3_f32 v16, v16, v17, v18
    v_max3_f32 v16, v16, v19, v20
    v_max3_f32 v16, v16, v21, v22
    v_max_f32 v16, v16, v23
    v_pk_add_f32 v[24:25], v[24:25], v[26:27]
    v_pk_add_f32 v[28:29], v[28:29], v[30:31]
    v_pk_add_f32 v[24:25], v[24:25], v[28:29]
    v_add_f32 v17, v24, v25
    s_mov_b32 s68, 0xfffffc00
    v_and_or_b32 v16, v16, s68, v2
    v_and_or_b32 v17, v17, s68, v2
    s_mov_b64 exec, 0xffff
    s_cmp_eq_u32 s71, 1
    s_cbranch_scc0 L_pl_20
    buffer_store_dwordx2 v[16:17], v3, s[16:19], s6 offen
L_pj_21:
    s_mov_b64 exec, -1
    s_add_u32 s65, s7, 32768
    s_add_u32 s64, s7, 16384
L_hdpoll:
    buffer_load_dwordx2 v[32:33], v11, s[16:19], s35 offen sc1
    buffer_load_dwordx2 v[34:35], v11, s[16:19], s35 offen offset:32 sc1
    s_waitcnt vmcnt(0)
    v_xor_b32 v32, s60, v32
    v_xor_b32 v33, s60, v33
    v_xor_b32 v34, s60, v34
    v_xor_b32 v35, s60, v35
    v_or3_b32 v1, v32, v33, v34
    v_or_b32 v1, v1, v35
    v_and_b32 v1, 0x3ff, v1
    v_cmp_ne_u32 vcc, 0, v1
    s_cbranch_vccz L_hdok
    s_sub_u32 s67, s67, 1
    s_cmp_gt_i32 s67, 0
    s_cbranch_scc1 L_hdpoll
L_hdok:
    v_mov_b32 v1, v32
    s_nop 1
    v_max_f32_dpp v1, v1, v1 quad_perm:[1,0,3,2] row_mask:0xf bank_mask:0xf
    s_nop 1
    v_max_f32_dpp v1, v1, v1 quad_perm:[2,3,0,1] row_mask:0xf bank_mask:0xf
    s_nop 1
    v_max_f32_dpp v1, v1, v1 row_half_mirror row_mask:0xf bank_mask:0xf
    v_sub_f32 v32, v32, v1
    v_mul_f32 v32, 0x3fb8aa3b, v32
    v_exp_f32 v32, v32
    s_nop 0
    v_mul_f32 v1, v32, v33
    s_nop 1
    v_add_f32_dpp v1, v1, v1 quad_perm:[1,0,3,2] row_mask:0xf bank_mask:0xf
    s_nop 1
    v_add_f32_dpp v1, v1, v1 quad_perm:[2,3,0,1] row_mask:0xf bank_mask:0xf
    s_nop 1
    v_add_f32_dpp v1, v1, v1 row_half_mirror row_mask:0xf bank_mask:0xf
    v_rcp_f32 v1, v1
    s_nop 0
    v_mul_f32 v1, v1, v32
    ds_write_b32 v9, v1
    s_mov_b64 exec, 1
    ds_add_u32 v160, v161 offset:24
    s_mov_b64 exec, -1
    s_cmp_ge_u32 s2, 128
    s_cbranch_scc1 L_anored
    s_mov_b64 exec, s[72:73]
    buffer_store_short v13, v12, s[28:31], 0 offen
    s_mov_b64 exec, -1
    buffer_load_dwordx4 v[100:103], v14, s[16:19], s7 offen sc1
    buffer_load_dwordx4 v[104:107], v14, s[16:19], s64 offen sc1
    buffer_load_dwordx4 v[108:111], v15, s[16:19], s65 offen sc1
    v_lshlrev_b32 v13, 16, v13
    s_mov_b64 s[10:11], 0
    s_branch L_t3fin
L_t3go:
    s_mov_b64 s[10:11], s[72:73]
    s_setprio 3
L_spin_22:
    ds_read_b32 v1, v160 offset:28
    s_waitcnt lgkmcnt(0)
    v_readfirstlane_b32 s4, v1
    s_cmp_lt_u32 s4, 8
    s_cbranch_scc1 L_spin_22
L_fpoll:
    buffer_load_dwordx4 v[36:39], v15, s[16:19], s65 offen sc1
    s_waitcnt vmcnt(0)
    v_xor_b32 v36, s60, v36
    v_xor_b32 v37, s60, v37
    v_xor_b32 v38, s60, v38
    v_xor_b32 v39, s60, v39
    v_or3_b32 v1, v36, v37, v38
    v_or_b32 v1, v1, v39
    v_and_b32 v1, 0x3ff, v1
    v_cmp_ne_u32 vcc, 0, v1
    s_cbranch_vccz L_fok
    s_sub_u32 s67, s67, 1
    s_cmp_gt_i32 s67, 0
    s_cbranch_scc1 L_fpoll
L_fok:
    v_cndmask_b32 v36, 0, v36, s[8:9]
    v_cndmask_b32 v37, 0, v37, s[8:9]
    v_cndmask_b32 v38, 0, v38, s[8:9]
    v_cndmask_b32 v39, 0, v39, s[8:9]
    s_nop 1
    v_permlane32_swap_b32 v36, v37
    v_permlane32_swap_b32 v38, v39
    v_add_f32 v36, v36, v37
    v_add_f32 v38, v38, v39
    s_nop 1
    v_permlane16_swap_b32 v36, v38
    v_add_f32 v36, v36, v38
    s_nop 1
    v_add_f32_dpp v36, v36, v36 row_ror:4 row_mask:0xf bank_mask:0xf
    s_nop 1
    v_add_f32_dpp v36, v36, v36 row_ror:8 row_mask:0xf bank_mask:0xf
    v_cvt_pk_bf16_f32 v36, v36, v36
    v_and_b32 v36, 0xffff0000, v36
    s_mov_b64 s[72:73], -1
    s_mov_b64 s[74:75], -1
    s_or_b64 exec, s[72:73], 1
    buffer_load_dwordx4 v[48:51], v14, s[16:19], s7 offen offset:0 sc1
    s_or_b64 exec, s[74:75], 1
    buffer_load_dwordx4 v[52:55], v14, s[16:19], s64 offen offset:0 sc1
L_t3poll:
    s_or_b64 exec, s[72:73], 1
    buffer_load_dwordx4 v[56:59], v14, s[16:19], s7 offen offset:0 sc1
    s_or_b64 exec, s[74:75], 1
    buffer_load_dwordx4 v[60:63], v14, s[16:19], s64 offen offset:0 sc1
    s_waitcnt vmcnt(3)
    s_mov_b64 exec, s[72:73]
    v_xor_b32 v48, s60, v48
    v_xor_b32 v49, s60, v49
    v_xor_b32 v50, s60, v50
    v_xor_b32 v51, s60, v51
    v_or3_b32 v1, v48, v49, v50
    v_or_b32 v1, v1, v51
    v_and_b32 v1, 0x3ff, v1
    v_cmp_ne_u32 vcc, 0, v1
    v_mov_b32 v16, v48
    v_mov_b32 v17, v49
    v_mov_b32 v18, v50
    v_mov_b32 v19, v51
    s_mov_b64 s[72:73], vcc
    s_waitcnt vmcnt(2)
    s_mov_b64 exec, s[74:75]
    v_xor_b32 v52, s60, v52
    v_xor_b32 v53, s60, v53
    v_xor_b32 v54, s60, v54
    v_xor_b32 v55, s60, v55
    v_or3_b32 v1, v52, v53, v54
    v_or_b32 v1, v1, v55
    v_and_b32 v1, 0x3ff, v1
    v_cmp_ne_u32 vcc, 0, v1
    v_mov_b32 v20, v52
    v_mov_b32 v21, v53
    v_mov_b32 v22, v54
    v_mov_b32 v23, v55
    s_mov_b64 s[74:75], vcc
    s_or_b64 s[76:77], s[72:73], s[74:75]
    s_cbranch_scc0 L_t3ok
    s_or_b64 exec, s[72:73], 1
    buffer_load_dwordx4 v[48:51], v14, s[16:19], s7 offen offset:0 sc1
    s_or_b64 exec, s[74:75], 1
    buffer_load_dwordx4 v[52:55], v14, s[16:19], s64 offen offset:0 sc1
    s_waitcnt vmcnt(3)
    s_mov_b64 exec, s[72:73]
    v_xor_b32 v56, s60, v56
    v_xor_b32 v57, s60, v57
    v_xor_b32 v58, s60, v58
    v_xor_b32 v59, s60, v59
    v_or3_b32 v1, v56, v57, v58
    v_or_b32 v1, v1, v59
    v_and_b32 v1, 0x3ff, v1
    v_cmp_ne_u32 vcc, 0, v1
    v_mov_b32 v16, v56
    v_mov_b32 v17, v57
    v_mov_b32 v18, v58
    v_mov_b32 v19, v59
    s_mov_b64 s[72:73], vcc
    s_waitcnt vmcnt(2)
    s_mov_b64 exec, s[74:75]
    v_xor_b32 v60, s60, v60
    v_xor_b32 v61, s60, v61
    v_xor_b32 v62, s60, v62
    v_xor_b32 v63, s60, v63
    v_or3_b32 v1, v60, v61, v62
    v_or_b32 v1, v1, v63
    v_and_b32 v1, 0x3ff, v1
    v_cmp_ne_u32 vcc, 0, v1
    v_mov_b32 v20, v60
    v_mov_b32 v21, v61
    v_mov_b32 v22, v62
    v_mov_b32 v23, v63
    s_mov_b64 s[74:75], vcc
    s_or_b64 s[76:77], s[72:73], s[74:75]
    s_cbranch_scc0 L_t3ok
    s_sub_u32 s67, s67, 1
    s_cmp_gt_i32 s67, 0
    s_cbranch_scc1 L_t3poll
L_t3ok:
    s_mov_b64 exec, -1
L_t3fin:
    v_add_f32 v16, v16, v20
    v_add_f32 v17, v17, v21
    v_add_f32 v18, v18, v22
    v_add_f32 v19, v19, v23
    s_nop 0
    v_permlane32_swap_b32 v16, v17
    v_permlane32_swap_b32 v18, v19
    v_add_f32 v16, v16, v17
    v_add_f32 v18, v18, v19
    s_nop 1
    v_permlane16_swap_b32 v16, v18
    v_add_f32 v16, v16, v18
    s_nop 1
    v_add_f32_dpp v16, v16, v16 row_ror:4 row_mask:0xf bank_mask:0xf
    s_cmp_eq_u32 s10, 0
    s_cbranch_scc1 L_t3go
    v_add_f32_dpp v16, v16, v16 row_ror:8 row_mask:0xf bank_mask:0xf
    v_cvt_pk_bf16_f32 v16, v16, v16
    v_and_b32 v16, 0xffff0000, v16
    v_add_f32 v16, v13, v16
    v_cvt_pk_bf16_f32 v16, v16, v16
    v_and_b32 v16, 0xffff0000, v16
    v_add_f32 v16, v16, v36
    v_cvt_pk_bf16_f32 v16, v16, v16
    s_mov_b64 exec, s[10:11]
    buffer_store_short v16, v12, s[28:31], 0 offen
    s_cmp_lg_u32 s2, 0
    s_cbranch_scc1 L_adone
    s_add_u32 s63, s58, 1
    v_mov_b32 v1, s63
    v_mov_b32 v2, 0
    s_mov_b64 exec, 1
    buffer_store_dword v1, v2, s[16:19], 0 offen
L_adone:
    s_endpgm
L_pl_20:
    buffer_store_dwordx2 v[16:17], v3, s[16:19], s6 offen sc1
    s_branch L_pj_21
L_anored:
    s_endpgm
L_b2:
    s_mov_b32 s72, 0xffff
    s_mov_b32 s73, 0x0
    s_mov_b32 s74, 0xffff0000
    s_mov_b32 s75, 0x0
    s_mov_b32 s76, 0x0
    s_mov_b32 s77, 0xffff
    s_mov_b32 s78, 0x0
    s_mov_b32 s79, 0xffff0000
    v_lshrrev_b32 v1, 5, v0
    v_and_b32 v2, 31, v0
    v_mul_u32_u24 v3, 28672, v1
    v_lshl_add_u32 v3, v2, 4, v3
    v_mul_u32_u24 v1, 272, v1
    v_lshl_add_u32 v6, v2, 3, v1
    v_add_u32 v6, 148608, v6
    s_lshl_b32 s33, s34, 9
    s_add_u32 s33, s33, 327680
    s_waitcnt lgkmcnt(0)
    s_add_u32 s63, s58, 1
    s_and_b32 s59, s63, 0xf
    s_and_b32 s60, s63, 0x3ff
    s_waitcnt vmcnt(1)
    ds_read_b64_tr_b16 v[96:97], v12 offset:0
    ds_read_b64_tr_b16 v[98:99], v12 offset:2048
    ds_read_b64_tr_b16 v[100:101], v12 offset:16384
    ds_read_b64_tr_b16 v[102:103], v12 offset:18432
    ds_read_b64_tr_b16 v[104:105], v12 offset:32768
    ds_read_b64_tr_b16 v[106:107], v12 offset:34816
    ds_read_b64_tr_b16 v[108:109], v12 offset:49152
    ds_read_b64_tr_b16 v[110:111], v12 offset:51200
    ds_read_b64_tr_b16 v[112:113], v13 offset:0
    ds_read_b64_tr_b16 v[114:115], v13 offset:2048
    ds_read_b64_tr_b16 v[116:117], v13 offset:16384
    ds_read_b64_tr_b16 v[118:119], v13 offset:18432
    ds_read_b64_tr_b16 v[120:121], v13 offset:32768
    ds_read_b64_tr_b16 v[122:123], v13 offset:34816
    ds_read_b64_tr_b16 v[124:125], v13 offset:49152
    ds_read_b64_tr_b16 v[126:127], v13 offset:51200
    ds_read_b64_tr_b16 v[128:129], v14 offset:0
    ds_read_b64_tr_b16 v[130:131], v14 offset:2048
    ds_read_b64_tr_b16 v[132:133], v14 offset:16384
    ds_read_b64_tr_b16 v[134:135], v14 offset:18432
    ds_read_b64_tr_b16 v[136:137], v14 offset:32768
    ds_read_b64_tr_b16 v[138:139], v14 offset:34816
    ds_read_b64_tr_b16 v[140:141], v14 offset:49152
    ds_read_b64_tr_b16 v[142:143], v14 offset:51200
    ds_read_b64_tr_b16 v[144:145], v15 offset:0
    ds_read_b64_tr_b16 v[146:147], v15 offset:2048
    ds_read_b64_tr_b16 v[148:149], v15 offset:16384
    ds_read_b64_tr_b16 v[150:151], v15 offset:18432
    ds_read_b64_tr_b16 v[152:153], v15 offset:32768
    ds_read_b64_tr_b16 v[154:155], v15 offset:34816
    ds_read_b64_tr_b16 v[156:157], v15 offset:49152
    ds_read_b64_tr_b16 v[158:159], v15 offset:51200
    s_mov_b64 exec, 1
    ds_add_u32 v160, v161 offset:12
    s_mov_b64 exec, -1
L_spin_23:
    ds_read_b32 v1, v160 offset:0
    s_waitcnt lgkmcnt(0)
    v_readfirstlane_b32 s4, v1
    s_cmp_lt_u32 s4, 1
    s_cbranch_scc1 L_spin_23
L_hpoll:
    s_add_u32 s63, s33, 0
    buffer_load_dwordx4 v[40:43], v3, s[16:19], s63 offen sc1
    s_add_u32 s63, s33, 57344
    buffer_load_dwordx4 v[44:47], v3, s[16:19], s63 offen sc1
    s_add_u32 s63, s33, 7168
    buffer_load_dwordx4 v[48:51], v3, s[16:19], s63 offen sc1
    s_add_u32 s63, s33, 64512
    buffer_load_dwordx4 v[52:55], v3, s[16:19], s63 offen sc1
    s_add_u32 s63, s33, 14336
    buffer_load_dwordx4 v[56:59], v3, s[16:19], s63 offen sc1
    s_add_u32 s63, s33, 71680
    buffer_load_dwordx4 v[60:63], v3, s[16:19], s63 offen sc1
    s_add_u32 s63, s33, 21504
    buffer_load_dwordx4 v[64:67], v3, s[16:19], s63 offen sc1
    s_add_u32 s63, s33, 78848
    buffer_load_dwordx4 v[68:71], v3, s[16:19], s63 offen sc1
    s_waitcnt vmcnt(0)
    v_xor_b32 v40, s59, v40
    v_xor_b32 v41, s59, v41
    v_xor_b32 v42, s59, v42
    v_xor_b32 v43, s59, v43
    v_xor_b32 v44, s59, v44
    v_xor_b32 v45, s59, v45
    v_xor_b32 v46, s59, v46
    v_xor_b32 v47, s59, v47
    v_xor_b32 v48, s59, v48
    v_xor_b32 v49, s59, v49
    v_xor_b32 v50, s59, v50
    v_xor_b32 v51, s59, v51
    v_xor_b32 v52, s59, v52
    v_xor_b32 v53, s59, v53
    v_xor_b32 v54, s59, v54
    v_xor_b32 v55, s59, v55
    v_xor_b32 v56, s59, v56
    v_xor_b32 v57, s59, v57
    v_xor_b32 v58, s59, v58
    v_xor_b32 v59, s59, v59
    v_xor_b32 v60, s59, v60
    v_xor_b32 v61, s59, v61
    v_xor_b32 v62, s59, v62
    v_xor_b32 v63, s59, v63
    v_xor_b32 v64, s59, v64
    v_xor_b32 v65, s59, v65
    v_xor_b32 v66, s59, v66
    v_xor_b32 v67, s59, v67
    v_xor_b32 v68, s59, v68
    v_xor_b32 v69, s59, v69
    v_xor_b32 v70, s59, v70
    v_xor_b32 v71, s59, v71
    v_or3_b32 v1, v40, v41, v42
    v_or3_b32 v1, v1, v43, v44
    v_or3_b32 v1, v1, v45, v46
    v_or3_b32 v1, v1, v47, v48
    v_or3_b32 v1, v1, v49, v50
    v_or3_b32 v1, v1, v51, v52
    v_or3_b32 v1, v1, v53, v54
    v_or3_b32 v1, v1, v55, v56
    v_or3_b32 v1, v1, v57, v58
    v_or3_b32 v1, v1, v59, v60
    v_or3_b32 v1, v1, v61, v62
    v_or3_b32 v1, v1, v63, v64
    v_or3_b32 v1, v1, v65, v66
    v_or3_b32 v1, v1, v67, v68
    v_or3_b32 v1, v1, v69, v70
    v_or_b32 v1, v1, v71
    v_and_b32 v1, 0xf, v1
    v_cmp_ne_u32 vcc, 0, v1
    s_cbranch_vccz L_hok
    s_sub_u32 s67, s67, 1
    s_cmp_gt_i32 s67, 0
    s_cbranch_scc1 L_hpoll
L_hok:
    v_pk_add_f32 v[40:41], v[40:41], v[48:49]
    v_pk_add_f32 v[42:43], v[42:43], v[50:51]
    v_pk_add_f32 v[44:45], v[44:45], v[52:53]
    v_pk_add_f32 v[46:47], v[46:47], v[54:55]
    v_pk_add_f32 v[40:41], v[40:41], v[56:57]
    v_pk_add_f32 v[42:43], v[42:43], v[58:59]
    v_pk_add_f32 v[44:45], v[44:45], v[60:61]
    v_pk_add_f32 v[46:47], v[46:47], v[62:63]
    v_pk_add_f32 v[40:41], v[40:41], v[64:65]
    v_pk_add_f32 v[42:43], v[42:43], v[66:67]
    v_pk_add_f32 v[44:45], v[44:45], v[68:69]
    v_pk_add_f32 v[46:47], v[46:47], v[70:71]
    v_cvt_pk_bf16_f32 v48, v40, v41
    v_cvt_pk_bf16_f32 v49, v42, v43
    v_cvt_pk_bf16_f32 v50, v44, v45
    v_cvt_pk_bf16_f32 v51, v46, v47
    v_lshlrev_b32 v40, 16, v48
    v_and_b32 v41, 0xffff0000, v48
    v_lshlrev_b32 v42, 16, v49
    v_and_b32 v43, 0xffff0000, v49
    v_lshlrev_b32 v44, 16, v50
    v_and_b32 v45, 0xffff0000, v50
    v_lshlrev_b32 v46, 16, v51
    v_and_b32 v47, 0xffff0000, v51
    v_mul_f32 v56, 0xbfb8aa3b, v40
    v_mul_f32 v57, 0xbfb8aa3b, v41
    v_mul_f32 v58, 0xbfb8aa3b, v42
    v_mul_f32 v59, 0xbfb8aa3b, v43
    v_mul_f32 v60, 0xbfb8aa3b, v44
    v_mul_f32 v61, 0xbfb8aa3b, v45
    v_mul_f32 v62, 0xbfb8aa3b, v46
    v_mul_f32 v63, 0xbfb8aa3b, v47
    v_exp_f32 v56, v56
    v_exp_f32 v57, v57
    v_exp_f32 v58, v58
    v_exp_f32 v59, v59
    v_exp_f32 v60, v60
    v_exp_f32 v61, v61
    v_exp_f32 v62, v62
    v_exp_f32 v63, v63
    v_add_f32 v56, 1.0, v56
    v_add_f32 v57, 1.0, v57
    v_add_f32 v58, 1.0, v58
    v_add_f32 v59, 1.0, v59
    v_add_f32 v60, 1.0, v60
    v_add_f32 v61, 1.0, v61
    v_add_f32 v62, 1.0, v62
    v_add_f32 v63, 1.0, v63
    v_rcp_f32 v56, v56
    v_rcp_f32 v57, v57
    v_rcp_f32 v58, v58
    v_rcp_f32 v59, v59
    v_rcp_f32 v60, v60
    v_rcp_f32 v61, v61
    v_rcp_f32 v62, v62
    v_rcp_f32 v63, v63
    v_mul_f32 v40, v40, v56
    v_mul_f32 v41, v41, v57
    v_mul_f32 v42, v42, v58
    v_mul_f32 v43, v43, v59
    v_mul_f32 v44, v44, v60
    v_mul_f32 v45, v45, v61
    v_mul_f32 v46, v46, v62
    v_mul_f32 v47, v47, v63
    v_cvt_pk_bf16_f32 v48, v40, v41
    v_cvt_pk_bf16_f32 v49, v42, v43
    v_cvt_pk_bf16_f32 v50, v44, v45
    v_cvt_pk_bf16_f32 v51, v46, v47
    ds_write_b64 v6, v[48:49]
    ds_write_b64 v6, v[50:51] offset:544
    s_waitcnt lgkmcnt(0)
    ds_read2_b64 v[80:83], v11 offset0:0 offset1:4
    ds_read2_b64 v[84:87], v11 offset0:8 offset1:12
    ds_read2_b64 v[88:91], v11 offset0:16 offset1:20
    ds_read2_b64 v[92:95], v11 offset0:24 offset1:28
    s_waitcnt lgkmcnt(0)
    v_mfma_f32_16x16x32_bf16 v[16:19], v[80:83], v[96:99], 0
    v_mfma_f32_16x16x32_bf16 v[20:23], v[80:83], v[112:115], 0
    v_mfma_f32_16x16x32_bf16 v[24:27], v[80:83], v[128:131], 0
    v_mfma_f32_16x16x32_bf16 v[28:31], v[80:83], v[144:147], 0
    v_mfma_f32_16x16x32_bf16 v[16:19], v[84:87], v[100:103], v[16:19]
    v_mfma_f32_16x16x32_bf16 v[20:23], v[84:87], v[116:119], v[20:23]
    v_mfma_f32_16x16x32_bf16 v[24:27], v[84:87], v[132:135], v[24:27]
    v_mfma_f32_16x16x32_bf16 v[28:31], v[84:87], v[148:151], v[28:31]
    v_mfma_f32_16x16x32_bf16 v[16:19], v[88:91], v[104:107], v[16:19]
    v_mfma_f32_16x16x32_bf16 v[20:23], v[88:91], v[120:123], v[20:23]
    v_mfma_f32_16x16x32_bf16 v[24:27], v[88:91], v[136:139], v[24:27]
    v_mfma_f32_16x16x32_bf16 v[28:31], v[88:91], v[152:155], v[28:31]
    v_mfma_f32_16x16x32_bf16 v[16:19], v[92:95], v[108:111], v[16:19]
    v_mfma_f32_16x16x32_bf16 v[20:23], v[92:95], v[124:127], v[20:23]
    v_mfma_f32_16x16x32_bf16 v[24:27], v[92:95], v[140:143], v[24:27]
    v_mfma_f32_16x16x32_bf16 v[28:31], v[92:95], v[156:159], v[28:31]
    s_nop 7
    v_cndmask_b32 v16, v16, v20, s[74:75]
    v_cndmask_b32 v17, v17, v21, s[74:75]
    v_cndmask_b32 v18, v18, v22, s[74:75]
    v_cndmask_b32 v19, v19, v23, s[74:75]
    v_cndmask_b32 v16, v16, v24, s[76:77]
    v_cndmask_b32 v17, v17, v25, s[76:77]
    v_cndmask_b32 v18, v18, v26, s[76:77]
    v_cndmask_b32 v19, v19, v27, s[76:77]
    v_cndmask_b32 v16, v16, v28, s[78:79]
    v_cndmask_b32 v17, v17, v29, s[78:79]
    v_cndmask_b32 v18, v18, v30, s[78:79]
    v_cndmask_b32 v19, v19, v31, s[78:79]
    v_mov_b32 v9, s60
    s_mov_b32 s68, 0xfffffc00
    v_and_or_b32 v16, v16, s68, v9
    v_and_or_b32 v17, v17, s68, v9
    v_and_or_b32 v18, v18, s68, v9
    v_and_or_b32 v19, v19, s68, v9
    s_mul_i32 s63, s35, 48
    s_add_u32 s63, s63, s34
    s_add_u32 s63, s63, 32
    s_lshl_b32 s63, s63, 10
    s_add_u32 s63, s63, 1048576
L_spin_24:
    ds_read_b32 v1, v160 offset:20
    s_waitcnt lgkmcnt(0)
    v_readfirstlane_b32 s4, v1
    s_cmp_lt_u32 s4, 1
    s_cbranch_scc1 L_spin_24
    buffer_store_dwordx4 v[16:19], v8, s[16:19], s63 offen sc1
L_end:
    s_endpgm
.section .rodata,"a"
.p2align 6
.amdhsa_kernel parallel_sum__gqa_block_cached__dense_activation_silu__decode_kernel
  .amdhsa_next_free_vgpr 167
  .amdhsa_next_free_sgpr 102
  .amdhsa_accum_offset 168
  .amdhsa_group_segment_fixed_size 0
  .amdhsa_kernarg_size 88
  .amdhsa_user_sgpr_count 2
  .amdhsa_user_sgpr_kernarg_segment_ptr 1
  .amdhsa_system_sgpr_workgroup_id_x 1
  .amdhsa_float_denorm_mode_32 3
.end_amdhsa_kernel
```
